```python
import torch

def _softmax(x, axis=-1):
    return torch.softmax(x, dim=axis)
def _gelu(x):
    return torch.nn.functional.gelu(x, approximate="tanh")
def _silu(x):
    return torch.nn.functional.silu(x)
def _sigmoid(x):
    return torch.sigmoid(x)
def _layernorm(x, axis=-1, eps=1e-5):
    m = x.mean(dim=axis, keepdim=True)
    v = x.var(dim=axis, keepdim=True, unbiased=False)
    return (x - m) / torch.sqrt(v + eps)
def _scatter_add(tgt, idx, src, axis=0):
    return tgt.clone().index_add_(axis, idx, src)
def _segment_sum(src, seg, n):
    out = torch.zeros((n,) + src.shape[1:], dtype=src.dtype)
    return out.index_add_(0, seg, src)
def _pad(x, pw):
    flat = tuple(v for pair in reversed(pw) for v in pair)
    return torch.nn.functional.pad(x, flat)

kernel_name = 'sequential_preLN__mha_block_cached__moe_arch_mod__decode'

def setup_inputs():

    _w = (lambda a: (lambda t: t.to(torch.bfloat16) if t.is_floating_point() else t)(torch.as_tensor(a)))
    def _A_setup():
        B, Sq, D = 1, 1, 640
        H, Sk, Dh = 32, 32768, 192
        return {
            "x": _w((lambda *s: torch.randn(*s, dtype=torch.bfloat16) * 0.05)(B, Sq, D)),
            "k_cache": _w((lambda *s: torch.randn(*s, dtype=torch.bfloat16) * 3.2)(B, H, Sk, Dh)),
            "v_cache": _w((lambda *s: torch.randn(*s, dtype=torch.bfloat16) * 0.4)(B, H, Sk, Dh)),
            "wq": _w((lambda *s: torch.randn(*s, dtype=torch.bfloat16) * 3.2)(D, H * Dh) * (D ** -0.5)),
            "wo": _w((lambda *s: torch.randn(*s, dtype=torch.bfloat16) * 0.4)(H * Dh, D) * ((H * Dh) ** -0.5)),
        }
    _A_in = _A_setup()

    def _B_setup():
        B, S, D, F, C = 1, 1, 640, 1536, 1
        return {
            "x": _w((lambda *s: torch.randn(*s, dtype=torch.bfloat16) * 0.05)(B, S, D)),
            "w_r": _w((lambda *s: torch.randn(*s, dtype=torch.bfloat16) * 0.05)(D)),
            "w_gate": _w((lambda *s: torch.randn(*s, dtype=torch.bfloat16) * 0.05)(D, F)),
            "w_up": _w((lambda *s: torch.randn(*s, dtype=torch.bfloat16) * 0.05)(D, F)),
            "w_down": _w((lambda *s: torch.randn(*s, dtype=torch.bfloat16) * 0.05)(F, D)),
        }
    _B_in = _B_setup()

    return {
        "A_x": _A_in["x"],
        "A_k_cache": _A_in["k_cache"],
        "A_v_cache": _A_in["v_cache"],
        "A_wq": _A_in["wq"],
        "A_wo": _A_in["wo"],
        "B_x": _B_in["x"],
        "B_w_r": _B_in["w_r"],
        "B_w_gate": _B_in["w_gate"],
        "B_w_up": _B_in["w_up"],
        "B_w_down": _B_in["w_down"],
    }

def reference(A_x, A_k_cache, A_v_cache, A_wq, A_wo, B_x, B_w_r, B_w_gate, B_w_up, B_w_down):
    def _A_ref(x, k_cache, v_cache, wq, wo):
        B, Sq, D = x.shape
        H, Dh = 32, 192
        q = (lambda x, *d: x.permute(*d))((x @ wq).reshape(B, Sq, H, Dh), 0, 2, 1, 3)
        scores = torch.einsum("bhqd,bhkd->bhqk", q, k_cache) * (Dh ** -0.5)
        p = _softmax(scores, axis=-1)
        o = torch.einsum("bhqk,bhkd->bhqd", p, v_cache)
        return (lambda x, *d: x.permute(*d))(o, 0, 2, 1, 3).reshape(B, Sq, H * Dh) @ wo

    def _B_ref(x, w_r, w_gate, w_up, w_down):
        B, S, D = x.shape
        C = 1
        r = x @ w_r
        idx = torch.argsort(-r, axis=-1)[:, :C]
        idx_e = (lambda x, n, axis: torch.repeat_interleave(x, n, dim=axis))(idx.reshape(B, C, 1), D, axis=2)
        x_sel = (lambda x, i, axis: torch.take_along_dim(x, i, dim=axis))(x, idx_e, axis=1)
        g = _silu(x_sel @ w_gate)
        u = x_sel @ w_up
        y = (g * u) @ w_down
        r_sel = _sigmoid((lambda x, i, axis: torch.take_along_dim(x, i, dim=axis))(r, idx, axis=1))
        y = y * r_sel.reshape(B, C, 1)
        b_off = (torch.arange(B) * S).reshape(B, 1)
        flat_idx = (idx + b_off).reshape(B * C)
        zero = (x * 0.0).reshape(B * S, D)
        upd = _scatter_add(zero, flat_idx, y.reshape(B * C, D), axis=0)
        return x + upd.reshape(B, S, D)

    x = A_x
    h = x + _A_ref(_layernorm(x, axis=-1), A_k_cache, A_v_cache, A_wq, A_wo)
    h2 = h + _B_ref(_layernorm(h, axis=-1), B_w_r, B_w_gate, B_w_up, B_w_down)
    return h2
```

```asm
; @launch grid=(256,1,1) block=(256,1,1) lds=55296
.amdgcn_target "amdgcn-amd-amdhsa--gfx950"
.text
.globl sequential_preLN__mha_block_cached__moe_arch_mod__decode_kernel
.p2align 8
.type sequential_preLN__mha_block_cached__moe_arch_mod__decode_kernel,@function
sequential_preLN__mha_block_cached__moe_arch_mod__decode_kernel:
L_code_start:
    s_cmp_ge_u32 s2, 256
    s_cbranch_scc1 L_end_1
    s_load_dwordx16 s[36:51], s[0:1], 0
    s_load_dwordx8 s[52:59], s[0:1], 64
    s_load_dwordx2 s[60:61], s[0:1], 96
    v_lshrrev_b32 v1, 6, v0
    v_mov_b32 v3, 0
    v_readfirstlane_b32 s3, v1
    v_and_b32 v1, 63, v0
    v_lshrrev_b32 v42, 3, v1
    v_mul_u32_u24 v42, 384, v42
    v_and_b32 v43, 7, v1
    v_lshl_add_u32 v2, v43, 4, v42
    s_mov_b32 s30, 0x3d93cd3a
    s_mov_b32 s31, 0x3fb8aa3b
    s_lshr_b32 s32, s2, 3
    s_and_b32 s29, s2, 7
    s_lshl_b32 s33, s29, 2
    s_add_u32 s32, s32, s33
    s_and_b32 s28, s32, 31
    s_lshl_b32 s86, s28, 3
    s_add_u32 s86, s86, s29
    s_waitcnt lgkmcnt(0)
    s_mov_b32 s16, s60
    s_and_b32 s17, s61, 0xffff
    s_mov_b32 s18, 2359296
    s_mov_b32 s19, 0x20000
    s_mov_b32 s88, s60
    s_and_b32 s89, s61, 0xffff
    s_mov_b32 s90, 2359296
    s_mov_b32 s91, 0x20000
    s_mov_b32 s92, s60
    s_and_b32 s93, s61, 0xffff
    s_mov_b32 s94, 2359296
    s_mov_b32 s95, 0x20000
    s_mov_b32 s96, s60
    s_and_b32 s97, s61, 0xffff
    s_mov_b32 s98, 2359296
    s_mov_b32 s99, 0x20000
    s_mov_b32 s20, s36
    s_and_b32 s21, s37, 0xffff
    s_mov_b32 s22, 1280
    s_mov_b32 s23, 0x20000
    s_mov_b32 s24, s42
    s_and_b32 s25, s43, 0xffff
    s_mov_b32 s26, 7864320
    s_mov_b32 s27, 0x20000
    v_lshlrev_b32 v42, 2, v1
    s_mov_b32 s32, 950272
    buffer_load_dword v58, v3, s[16:19], s32 offen sc1
    buffer_load_dword v64, v42, s[20:23], 0 offen offset:0
    buffer_load_dword v65, v42, s[20:23], 0 offen offset:256
    buffer_load_dword v66, v42, s[20:23], 0 offen offset:512
    buffer_load_dword v67, v42, s[20:23], 0 offen offset:768
    buffer_load_dword v68, v42, s[20:23], 0 offen offset:1024
    v_lshrrev_b32 v43, 3, v1
    v_mul_u32_u24 v43, 12288, v43
    v_and_b32 v44, 7, v1
    v_lshl_add_u32 v43, v44, 4, v43
    s_mul_i32 s70, s29, 80
    s_lshl_b32 s33, s3, 3
    s_add_u32 s70, s70, s33
    s_mul_i32 s33, s70, 12288
    s_mul_i32 s34, s28, 384
    s_add_u32 s33, s33, s34
    buffer_load_dwordx4 v[80:83], v43, s[24:27], s33 offen offset:0 nt
    buffer_load_dwordx4 v[84:87], v43, s[24:27], s33 offen offset:128 nt
    buffer_load_dwordx4 v[88:91], v43, s[24:27], s33 offen offset:256 nt
    s_add_u32 s33, s33, 393216
    buffer_load_dwordx4 v[92:95], v43, s[24:27], s33 offen offset:0 nt
    buffer_load_dwordx4 v[96:99], v43, s[24:27], s33 offen offset:128 nt
    buffer_load_dwordx4 v[100:103], v43, s[24:27], s33 offen offset:256 nt
    s_add_u32 s33, s33, 393216
    s_cmp_ge_u32 s3, 2
    s_cbranch_scc1 L_q3_2
    buffer_load_dwordx4 v[104:107], v43, s[24:27], s33 offen offset:0 nt
    buffer_load_dwordx4 v[108:111], v43, s[24:27], s33 offen offset:128 nt
    buffer_load_dwordx4 v[112:115], v43, s[24:27], s33 offen offset:256 nt
    s_add_u32 s33, s33, 393216
L_q3_2:
    s_mov_b32 s8, s38
    s_and_b32 s9, s39, 0xffff
    s_mov_b32 s10, 402653184
    s_mov_b32 s11, 0x20000
    s_mov_b32 s12, s40
    s_and_b32 s13, s41, 0xffff
    s_mov_b32 s14, 402653184
    s_mov_b32 s15, 0x20000
    s_lshl_b32 s64, s28, 8
    s_add_u32 s64, s64, 262144
    s_cmp_ge_u32 s2, 160
    s_cbranch_scc0 L_mi_3
    s_sub_u32 s32, s2, 160
    s_and_b32 s33, s32, 7
    s_mul_i32 s33, s33, 12
    s_lshr_b32 s32, s32, 3
    s_add_u32 s67, s32, s33
L_mi_3:
    v_mov_b32 v44, -1
    v_mov_b32 v45, -1
    v_mov_b32 v46, -1
    v_mov_b32 v47, -1
    s_lshl_b32 s32, s86, 10
    s_add_u32 s32, s32, 327680
    v_lshlrev_b32 v42, 2, v0
    buffer_store_dword v44, v42, s[16:19], s32 offen sc1
    s_lshl_b32 s32, s86, 11
    s_add_u32 s32, s32, 1769472
    v_lshlrev_b32 v43, 3, v0
    buffer_store_dwordx2 v[44:45], v43, s[16:19], s32 offen sc1
    s_cmp_ge_u32 s2, 160
    s_cbranch_scc1 L_rm_4
    s_cmp_lg_u32 s3, 0
    s_cbranch_scc1 L_wc_6
    s_and_b32 s32, s2, 7
    s_mul_i32 s32, s32, 2560
    s_lshr_b32 s33, s2, 3
    s_lshl_b32 s33, s33, 7
    s_add_u32 s32, s32, s33
    s_add_u32 s32, s32, 1572864
    v_cmp_gt_u32 vcc, 32, v0
    s_and_saveexec_b64 s[34:35], vcc
    buffer_store_dword v44, v42, s[16:19], s32 offen sc1
    s_mov_b64 exec, s[34:35]
L_wc_6:
    s_branch L_re_5
L_rm_4:
    s_sub_u32 s32, s2, 160
    s_and_b32 s33, s32, 7
    s_mul_i32 s33, s33, 12
    s_lshr_b32 s32, s32, 3
    s_add_u32 s67, s32, s33
    s_cmp_ge_u32 s3, 3
    s_cbranch_scc1 L_mc_7
    v_lshrrev_b32 v42, 2, v0
    v_mul_u32_u24 v42, 6144, v42
    v_and_b32 v43, 3, v0
    v_lshl_add_u32 v42, v43, 4, v42
    s_lshl_b32 s32, s67, 6
    s_add_u32 s32, s32, 655360
    v_cmp_gt_u32 vcc, 160, v0
    s_and_saveexec_b64 s[34:35], vcc
    buffer_store_dwordx4 v[44:47], v42, s[16:19], s32 offen sc1
    s_mov_b64 exec, s[34:35]
L_mc_7:
L_re_5:
    s_lshl_b32 s64, s28, 8
    s_add_u32 s64, s64, 262144
    s_or_b32 s32, s29, s3
    s_cmp_lg_u32 s32, 0
    s_cbranch_scc1 L_cz_8
    s_mov_b64 exec, 1
    buffer_store_dword v3, v3, s[16:19], s64 offen sc1
    buffer_store_dword v3, v3, s[16:19], s64 offen offset:128 sc1
    s_mov_b64 exec, -1
L_cz_8:
    s_mul_i32 s63, s28, 12582912
    s_mul_i32 s76, s28, 11
    s_lshl_b32 s79, s29, 2
    s_add_u32 s79, s79, s3
    s_mov_b32 s78, 0
    s_lshl_b32 s69, s28, 14
    s_add_u32 s69, s69, 1769472
    s_or_b32 s71, s69, 0x80000000
    s_cmp_ge_u32 s3, 3
    s_cbranch_scc1 L_nopf_9
    s_getpc_b64 s[88:89]
L_pc_11:
    s_sub_u32 s88, s88, L_pc_11-L_code_start
    s_subb_u32 s89, s89, 0
    s_and_b32 s89, s89, 0xffff
    s_mov_b32 s90, L_code_end-L_code_start
    s_mov_b32 s91, 0x20000
    s_lshr_b32 s32, s2, 3
    s_mul_i32 s32, s32, (((L_code_end-L_code_start)+31)/32+15)&0xfffffff0
    v_lshlrev_b32 v42, 4, v1
    buffer_load_dwordx4 v[52:55], v42, s[88:91], s32 offen offset:0
    buffer_load_dwordx4 v[52:55], v42, s[88:91], s32 offen offset:1024
    s_waitcnt vmcnt(9)
    s_branch L_pfd_10
L_nopf_9:
    s_waitcnt vmcnt(7)
L_pfd_10:
    v_readfirstlane_b32 s77, v58
    v_lshlrev_b32 v70, 16, v64
    v_and_b32 v71, 0xffff0000, v64
    v_lshlrev_b32 v72, 16, v65
    v_and_b32 v73, 0xffff0000, v65
    v_lshlrev_b32 v74, 16, v66
    v_and_b32 v75, 0xffff0000, v66
    v_lshlrev_b32 v76, 16, v67
    v_and_b32 v77, 0xffff0000, v67
    v_lshlrev_b32 v78, 16, v68
    v_and_b32 v79, 0xffff0000, v68
    s_add_u32 s77, s77, 1
    v_mov_b32 v16, 0
    v_mov_b32 v17, 0
    v_mov_b32 v18, 0
    v_mov_b32 v19, 0
    v_mov_b32 v20, 0
    v_mov_b32 v21, 0
    v_mov_b32 v22, 0
    v_mov_b32 v23, 0
    v_mov_b32 v24, 0
    v_mov_b32 v25, 0
    v_mov_b32 v26, 0
    v_mov_b32 v27, 0
    v_mov_b32 v28, 0
    v_mov_b32 v29, 0
    v_mov_b32 v30, 0
    v_mov_b32 v31, 0
    v_mov_b32 v32, 0
    v_mov_b32 v33, 0
    v_mov_b32 v34, 0
    v_mov_b32 v35, 0
    v_mov_b32 v36, 0
    v_mov_b32 v37, 0
    v_mov_b32 v38, 0
    v_mov_b32 v39, 0
    s_nop 0
    v_readfirstlane_b32 s32, v70
    s_nop 1
    v_subrev_f32 v46, s32, v70
    v_mul_f32 v47, v46, v46
    v_subrev_f32 v48, s32, v71
    v_add_f32 v46, v46, v48
    v_fmac_f32 v47, v48, v48
    v_subrev_f32 v48, s32, v72
    v_add_f32 v46, v46, v48
    v_fmac_f32 v47, v48, v48
    v_subrev_f32 v48, s32, v73
    v_add_f32 v46, v46, v48
    v_fmac_f32 v47, v48, v48
    v_subrev_f32 v48, s32, v74
    v_add_f32 v46, v46, v48
    v_fmac_f32 v47, v48, v48
    v_subrev_f32 v48, s32, v75
    v_add_f32 v46, v46, v48
    v_fmac_f32 v47, v48, v48
    v_subrev_f32 v48, s32, v76
    v_add_f32 v46, v46, v48
    v_fmac_f32 v47, v48, v48
    v_subrev_f32 v48, s32, v77
    v_add_f32 v46, v46, v48
    v_fmac_f32 v47, v48, v48
    v_subrev_f32 v48, s32, v78
    v_add_f32 v46, v46, v48
    v_fmac_f32 v47, v48, v48
    v_subrev_f32 v48, s32, v79
    v_add_f32 v46, v46, v48
    v_fmac_f32 v47, v48, v48
    s_nop 1
    v_add_f32_dpp v46, v46, v46 quad_perm:[1,0,3,2] row_mask:0xf bank_mask:0xf
    v_add_f32_dpp v47, v47, v47 quad_perm:[1,0,3,2] row_mask:0xf bank_mask:0xf
    s_nop 1
    v_add_f32_dpp v46, v46, v46 quad_perm:[2,3,0,1] row_mask:0xf bank_mask:0xf
    v_add_f32_dpp v47, v47, v47 quad_perm:[2,3,0,1] row_mask:0xf bank_mask:0xf
    s_nop 1
    v_add_f32_dpp v46, v46, v46 row_half_mirror row_mask:0xf bank_mask:0xf
    v_add_f32_dpp v47, v47, v47 row_half_mirror row_mask:0xf bank_mask:0xf
    s_nop 1
    v_add_f32_dpp v46, v46, v46 row_mirror row_mask:0xf bank_mask:0xf
    v_add_f32_dpp v47, v47, v47 row_mirror row_mask:0xf bank_mask:0xf
    v_mov_b32 v48, v46
    v_mov_b32 v49, v47
    s_nop 1
    v_permlane16_swap_b32 v48, v46
    v_permlane16_swap_b32 v49, v47
    s_nop 0
    v_add_f32 v46, v46, v48
    v_add_f32 v47, v47, v49
    v_mov_b32 v48, v46
    v_mov_b32 v49, v47
    s_nop 1
    v_permlane32_swap_b32 v48, v46
    v_permlane32_swap_b32 v49, v47
    s_nop 0
    v_add_f32 v46, v46, v48
    v_add_f32 v47, v47, v49
    v_mul_f32 v46, 0x3acccccd, v46
    v_mul_f32 v47, 0x3acccccd, v47
    v_fma_f32 v47, -v46, v46, v47
    v_max_f32 v47, 0, v47
    v_add_f32 v51, s32, v46
    v_cvt_pk_bf16_f32 v47, v47, v47
    v_and_b32 v47, 0xffff0000, v47
    v_add_f32 v47, 0x3727c5ac, v47
    v_cvt_pk_bf16_f32 v47, v47, v47
    v_and_b32 v47, 0xffff0000, v47
    v_sqrt_f32 v50, v47
    v_cvt_pk_bf16_f32 v51, v51, v51
    v_and_b32 v51, 0xffff0000, v51
    v_cvt_pk_bf16_f32 v50, v50, v50
    v_and_b32 v50, 0xffff0000, v50
    v_rcp_f32 v50, v50
    v_sub_f32 v70, v70, v51
    v_sub_f32 v71, v71, v51
    v_cvt_pk_bf16_f32 v48, v70, v71
    v_lshlrev_b32 v70, 16, v48
    v_and_b32 v71, 0xffff0000, v48
    v_mul_f32 v70, v70, v50
    v_mul_f32 v71, v71, v50
    v_sub_f32 v72, v72, v51
    v_sub_f32 v73, v73, v51
    v_cvt_pk_bf16_f32 v48, v72, v73
    v_lshlrev_b32 v72, 16, v48
    v_and_b32 v73, 0xffff0000, v48
    v_mul_f32 v72, v72, v50
    v_mul_f32 v73, v73, v50
    v_sub_f32 v74, v74, v51
    v_sub_f32 v75, v75, v51
    v_cvt_pk_bf16_f32 v48, v74, v75
    v_lshlrev_b32 v74, 16, v48
    v_and_b32 v75, 0xffff0000, v48
    v_mul_f32 v74, v74, v50
    v_mul_f32 v75, v75, v50
    v_sub_f32 v76, v76, v51
    v_sub_f32 v77, v77, v51
    v_cvt_pk_bf16_f32 v48, v76, v77
    v_lshlrev_b32 v76, 16, v48
    v_and_b32 v77, 0xffff0000, v48
    v_mul_f32 v76, v76, v50
    v_mul_f32 v77, v77, v50
    v_sub_f32 v78, v78, v51
    v_sub_f32 v79, v79, v51
    v_cvt_pk_bf16_f32 v48, v78, v79
    v_lshlrev_b32 v78, 16, v48
    v_and_b32 v79, 0xffff0000, v48
    v_mul_f32 v78, v78, v50
    v_mul_f32 v79, v79, v50
    v_cvt_pk_bf16_f32 v64, v70, v71
    v_cvt_pk_bf16_f32 v65, v72, v73
    v_cvt_pk_bf16_f32 v66, v74, v75
    v_cvt_pk_bf16_f32 v67, v76, v77
    v_cvt_pk_bf16_f32 v68, v78, v79
    s_mul_i32 s34, s3, 1280
    v_lshlrev_b32 v42, 2, v1
    v_add_u32 v42, s34, v42
    ds_write_b32 v42, v64 offset:24576
    ds_write_b32 v42, v65 offset:24832
    ds_write_b32 v42, v66 offset:25088
    ds_write_b32 v42, v67 offset:25344
    ds_write_b32 v42, v68 offset:25600
    s_lshl_b32 s32, s70, 1
    s_add_u32 s32, s32, s34
    v_lshrrev_b32 v42, 3, v1
    v_lshlrev_b32 v42, 1, v42
    v_add_u32 v42, s32, v42
    s_waitcnt lgkmcnt(0)
    ds_read_u16 v64, v42 offset:24576
    ds_read_u16 v65, v42 offset:24640
    ds_read_u16 v66, v42 offset:24704
    s_cmp_ge_u32 s3, 3
    s_cbranch_scc1 L_w3_12
    s_waitcnt lgkmcnt(0) vmcnt(2)
    s_branch L_w3d_13
L_w3_12:
    s_waitcnt lgkmcnt(0) vmcnt(0)
L_w3d_13:
    s_cmp_ge_u32 s2, 160
    s_cbranch_scc1 L_rm_15
    s_mov_b32 s88, s44
    s_and_b32 s89, s45, 0xffff
    s_mov_b32 s90, 7864320
    s_mov_b32 s91, 0x20000
    s_and_b32 s32, s2, 7
    s_mul_i32 s32, s32, 768
    s_mul_i32 s33, s3, 192
    s_add_u32 s32, s32, s33
    s_mul_i32 s32, s32, 1280
    s_lshr_b32 s33, s2, 3
    s_lshl_b32 s33, s33, 6
    s_add_u32 s87, s32, s33
    v_lshrrev_b32 v48, 2, v1
    v_mul_u32_u24 v48, 1280, v48
    v_and_b32 v49, 3, v1
    v_lshl_add_u32 v48, v49, 4, v48
    s_branch L_re_16
L_rm_15:
    s_cmp_ge_u32 s3, 2
    s_cselect_b32 s32, s52, s50
    s_cselect_b32 s33, s53, s51
    s_mov_b32 s88, s32
    s_and_b32 s89, s33, 0xffff
    s_mov_b32 s90, 1966080
    s_mov_b32 s91, 0x20000
    s_mov_b32 s92, s54
    s_and_b32 s93, s55, 0xffff
    s_mov_b32 s94, 1966080
    s_mov_b32 s95, 0x20000
    v_and_b32 v49, 127, v0
    v_lshrrev_b32 v48, 1, v49
    v_mul_u32_u24 v48, 3072, v48
    v_and_b32 v49, 1, v49
    v_lshl_add_u32 v48, v49, 4, v48
    s_lshl_b32 s87, s67, 5
    v_mul_u32_u24 v49, 205, v0
    v_lshrrev_b32 v49, 14, v49
    v_mul_u32_u24 v50, 80, v49
    v_sub_u32 v50, v0, v50
    v_mul_u32_u24 v49, 1280, v49
    v_lshl_add_u32 v49, v50, 4, v49
    s_mul_i32 s100, s67, 20480
L_re_16:
    s_cmp_ge_u32 s3, 3
    s_cbranch_scc1 L_ske_14
    s_cmp_ge_u32 s2, 160
    s_cbranch_scc1 L_rm_17
    buffer_load_dwordx4 v[192:195], v48, s[88:91], s87 offen nt
    s_add_u32 s87, s87, 20480
    buffer_load_dwordx4 v[196:199], v48, s[88:91], s87 offen nt
    s_add_u32 s87, s87, 20480
    buffer_load_dwordx4 v[200:203], v48, s[88:91], s87 offen nt
    s_add_u32 s87, s87, 20480
    buffer_load_dwordx4 v[204:207], v48, s[88:91], s87 offen nt
    s_add_u32 s87, s87, 20480
    buffer_load_dwordx4 v[208:211], v48, s[88:91], s87 offen nt
    s_add_u32 s87, s87, 20480
    buffer_load_dwordx4 v[212:215], v48, s[88:91], s87 offen nt
    s_add_u32 s87, s87, 20480
    s_branch L_re_18
L_rm_17:
    buffer_load_dwordx4 v[232:235], v49, s[92:95], s100 offen nt
    s_add_u32 s100, s100, 3840
    buffer_load_dwordx4 v[236:239], v49, s[92:95], s100 offen nt
    s_add_u32 s100, s100, 3840
    buffer_load_dwordx4 v[240:243], v49, s[92:95], s100 offen nt
    s_add_u32 s100, s100, 3840
    buffer_load_dwordx4 v[244:247], v49, s[92:95], s100 offen nt
    s_add_u32 s100, s100, 3840
    buffer_load_dwordx4 v[248:251], v49, s[92:95], s100 offen nt
    s_add_u32 s100, s100, 3840
    buffer_load_dwordx4 v[252:255], v49, s[92:95], s100 offen nt
    s_add_u32 s100, s100, 3840
L_re_18:
L_ske_14:
    v_lshlrev_b32 v68, 16, v64
    v_dot2_f32_bf16 v16, v80, v64, v16
    v_dot2_f32_bf16 v17, v80, v68, v17
    v_dot2_f32_bf16 v18, v81, v64, v18
    v_dot2_f32_bf16 v19, v81, v68, v19
    v_dot2_f32_bf16 v20, v82, v64, v20
    v_dot2_f32_bf16 v21, v82, v68, v21
    v_dot2_f32_bf16 v22, v83, v64, v22
    v_dot2_f32_bf16 v23, v83, v68, v23
    v_dot2_f32_bf16 v24, v84, v64, v24
    v_dot2_f32_bf16 v25, v84, v68, v25
    v_dot2_f32_bf16 v26, v85, v64, v26
    v_dot2_f32_bf16 v27, v85, v68, v27
    v_dot2_f32_bf16 v28, v86, v64, v28
    v_dot2_f32_bf16 v29, v86, v68, v29
    v_dot2_f32_bf16 v30, v87, v64, v30
    v_dot2_f32_bf16 v31, v87, v68, v31
    v_dot2_f32_bf16 v32, v88, v64, v32
    v_dot2_f32_bf16 v33, v88, v68, v33
    v_dot2_f32_bf16 v34, v89, v64, v34
    v_dot2_f32_bf16 v35, v89, v68, v35
    v_dot2_f32_bf16 v36, v90, v64, v36
    v_dot2_f32_bf16 v37, v90, v68, v37
    v_dot2_f32_bf16 v38, v91, v64, v38
    v_dot2_f32_bf16 v39, v91, v68, v39
    v_lshlrev_b32 v68, 16, v65
    v_dot2_f32_bf16 v16, v92, v65, v16
    v_dot2_f32_bf16 v17, v92, v68, v17
    v_dot2_f32_bf16 v18, v93, v65, v18
    v_dot2_f32_bf16 v19, v93, v68, v19
    v_dot2_f32_bf16 v20, v94, v65, v20
    v_dot2_f32_bf16 v21, v94, v68, v21
    v_dot2_f32_bf16 v22, v95, v65, v22
    v_dot2_f32_bf16 v23, v95, v68, v23
    v_dot2_f32_bf16 v24, v96, v65, v24
    v_dot2_f32_bf16 v25, v96, v68, v25
    v_dot2_f32_bf16 v26, v97, v65, v26
    v_dot2_f32_bf16 v27, v97, v68, v27
    v_dot2_f32_bf16 v28, v98, v65, v28
    v_dot2_f32_bf16 v29, v98, v68, v29
    v_dot2_f32_bf16 v30, v99, v65, v30
    v_dot2_f32_bf16 v31, v99, v68, v31
    v_dot2_f32_bf16 v32, v100, v65, v32
    v_dot2_f32_bf16 v33, v100, v68, v33
    v_dot2_f32_bf16 v34, v101, v65, v34
    v_dot2_f32_bf16 v35, v101, v68, v35
    v_dot2_f32_bf16 v36, v102, v65, v36
    v_dot2_f32_bf16 v37, v102, v68, v37
    v_dot2_f32_bf16 v38, v103, v65, v38
    v_dot2_f32_bf16 v39, v103, v68, v39
    s_cmp_ge_u32 s3, 2
    s_cbranch_scc1 L_q3b_19
    v_lshlrev_b32 v68, 16, v66
    v_dot2_f32_bf16 v16, v104, v66, v16
    v_dot2_f32_bf16 v17, v104, v68, v17
    v_dot2_f32_bf16 v18, v105, v66, v18
    v_dot2_f32_bf16 v19, v105, v68, v19
    v_dot2_f32_bf16 v20, v106, v66, v20
    v_dot2_f32_bf16 v21, v106, v68, v21
    v_dot2_f32_bf16 v22, v107, v66, v22
    v_dot2_f32_bf16 v23, v107, v68, v23
    v_dot2_f32_bf16 v24, v108, v66, v24
    v_dot2_f32_bf16 v25, v108, v68, v25
    v_dot2_f32_bf16 v26, v109, v66, v26
    v_dot2_f32_bf16 v27, v109, v68, v27
    v_dot2_f32_bf16 v28, v110, v66, v28
    v_dot2_f32_bf16 v29, v110, v68, v29
    v_dot2_f32_bf16 v30, v111, v66, v30
    v_dot2_f32_bf16 v31, v111, v68, v31
    v_dot2_f32_bf16 v32, v112, v66, v32
    v_dot2_f32_bf16 v33, v112, v68, v33
    v_dot2_f32_bf16 v34, v113, v66, v34
    v_dot2_f32_bf16 v35, v113, v68, v35
    v_dot2_f32_bf16 v36, v114, v66, v36
    v_dot2_f32_bf16 v37, v114, v68, v37
    v_dot2_f32_bf16 v38, v115, v66, v38
    v_dot2_f32_bf16 v39, v115, v68, v39
L_q3b_19:
    s_nop 2
    v_add_f32_dpp v16, v16, v16 row_ror:8 row_mask:0xf bank_mask:0xf
    v_add_f32_dpp v17, v17, v17 row_ror:8 row_mask:0xf bank_mask:0xf
    v_add_f32_dpp v18, v18, v18 row_ror:8 row_mask:0xf bank_mask:0xf
    v_add_f32_dpp v19, v19, v19 row_ror:8 row_mask:0xf bank_mask:0xf
    v_add_f32_dpp v20, v20, v20 row_ror:8 row_mask:0xf bank_mask:0xf
    v_add_f32_dpp v21, v21, v21 row_ror:8 row_mask:0xf bank_mask:0xf
    v_add_f32_dpp v22, v22, v22 row_ror:8 row_mask:0xf bank_mask:0xf
    v_add_f32_dpp v23, v23, v23 row_ror:8 row_mask:0xf bank_mask:0xf
    v_add_f32_dpp v24, v24, v24 row_ror:8 row_mask:0xf bank_mask:0xf
    v_add_f32_dpp v25, v25, v25 row_ror:8 row_mask:0xf bank_mask:0xf
    v_add_f32_dpp v26, v26, v26 row_ror:8 row_mask:0xf bank_mask:0xf
    v_add_f32_dpp v27, v27, v27 row_ror:8 row_mask:0xf bank_mask:0xf
    v_add_f32_dpp v28, v28, v28 row_ror:8 row_mask:0xf bank_mask:0xf
    v_add_f32_dpp v29, v29, v29 row_ror:8 row_mask:0xf bank_mask:0xf
    v_add_f32_dpp v30, v30, v30 row_ror:8 row_mask:0xf bank_mask:0xf
    v_add_f32_dpp v31, v31, v31 row_ror:8 row_mask:0xf bank_mask:0xf
    v_add_f32_dpp v32, v32, v32 row_ror:8 row_mask:0xf bank_mask:0xf
    v_add_f32_dpp v33, v33, v33 row_ror:8 row_mask:0xf bank_mask:0xf
    v_add_f32_dpp v34, v34, v34 row_ror:8 row_mask:0xf bank_mask:0xf
    v_add_f32_dpp v35, v35, v35 row_ror:8 row_mask:0xf bank_mask:0xf
    v_add_f32_dpp v36, v36, v36 row_ror:8 row_mask:0xf bank_mask:0xf
    v_add_f32_dpp v37, v37, v37 row_ror:8 row_mask:0xf bank_mask:0xf
    v_add_f32_dpp v38, v38, v38 row_ror:8 row_mask:0xf bank_mask:0xf
    v_add_f32_dpp v39, v39, v39 row_ror:8 row_mask:0xf bank_mask:0xf
    s_nop 1
    v_permlane16_swap_b32 v16, v28
    v_permlane16_swap_b32 v17, v29
    v_permlane16_swap_b32 v18, v30
    v_permlane16_swap_b32 v19, v31
    v_permlane16_swap_b32 v20, v32
    v_permlane16_swap_b32 v21, v33
    v_permlane16_swap_b32 v22, v34
    v_permlane16_swap_b32 v23, v35
    v_permlane16_swap_b32 v24, v36
    v_permlane16_swap_b32 v25, v37
    v_permlane16_swap_b32 v26, v38
    v_permlane16_swap_b32 v27, v39
    s_nop 0
    v_pk_add_f32 v[16:17], v[16:17], v[28:29]
    v_pk_add_f32 v[18:19], v[18:19], v[30:31]
    v_pk_add_f32 v[20:21], v[20:21], v[32:33]
    v_pk_add_f32 v[22:23], v[22:23], v[34:35]
    v_pk_add_f32 v[24:25], v[24:25], v[36:37]
    v_pk_add_f32 v[26:27], v[26:27], v[38:39]
    v_and_b32 v42, 7, v1
    v_mul_u32_u24 v42, 96, v42
    v_bfe_u32 v43, v1, 4, 1
    v_mul_u32_u24 v43, 48, v43
    v_add_u32 v42, v42, v43
    v_lshrrev_b32 v43, 5, v1
    v_mul_u32_u24 v43, 24, v43
    s_mul_i32 s32, s3, 768
    v_add3_u32 v42, v42, v43, s32
    s_nop 1
    v_permlane32_swap_b32 v16, v22
    v_permlane32_swap_b32 v17, v23
    v_permlane32_swap_b32 v18, v24
    v_permlane32_swap_b32 v19, v25
    v_permlane32_swap_b32 v20, v26
    v_permlane32_swap_b32 v21, v27
    s_nop 0
    v_pk_add_f32 v[16:17], v[16:17], v[22:23]
    v_pk_add_f32 v[18:19], v[18:19], v[24:25]
    v_pk_add_f32 v[20:21], v[20:21], v[26:27]
    ds_write_b64 v42, v[16:17] offset:0
    ds_write_b64 v42, v[18:19] offset:8
    ds_write_b64 v42, v[20:21] offset:16
    s_waitcnt lgkmcnt(0)
    s_barrier
    s_cmp_ge_u32 s3, 3
    s_cbranch_scc1 L_gat_20
    v_lshlrev_b32 v42, 2, v0
    ds_read_b32 v96, v42 offset:0
    ds_read_b32 v97, v42 offset:768
    ds_read_b32 v98, v42 offset:1536
    ds_read_b32 v99, v42 offset:2304
    s_lshl_b32 s32, s86, 11
    s_add_u32 s32, s32, 1048576
    v_lshlrev_b32 v42, 3, v0
    s_waitcnt lgkmcnt(0)
    v_add_f32 v96, v96, v97
    v_add_f32 v98, v98, v99
    v_mov_b32 v97, s77
    v_add_f32 v96, v96, v98
    buffer_store_dwordx2 v[96:97], v42, s[16:19], s32 offen sc1
    s_cmp_ge_u32 s2, 160
    s_cbranch_scc1 L_rm_22
    buffer_load_dwordx4 v[216:219], v48, s[88:91], s87 offen nt
    s_add_u32 s87, s87, 20480
    buffer_load_dwordx4 v[220:223], v48, s[88:91], s87 offen nt
    s_add_u32 s87, s87, 20480
    buffer_load_dwordx4 v[224:227], v48, s[88:91], s87 offen nt
    s_add_u32 s87, s87, 20480
    buffer_load_dwordx4 v[228:231], v48, s[88:91], s87 offen nt
    s_add_u32 s87, s87, 20480
    buffer_load_dwordx4 v[232:235], v48, s[88:91], s87 offen nt
    s_add_u32 s87, s87, 20480
    buffer_load_dwordx4 v[236:239], v48, s[88:91], s87 offen nt
    s_add_u32 s87, s87, 20480
    s_branch L_re_23
L_rm_22:
    buffer_load_dwordx4 v[192:195], v48, s[88:91], s87 offen nt
    s_add_u32 s87, s87, 196608
    buffer_load_dwordx4 v[196:199], v48, s[88:91], s87 offen nt
    s_add_u32 s87, s87, 196608
    buffer_load_dwordx4 v[200:203], v48, s[88:91], s87 offen nt
    s_add_u32 s87, s87, 196608
    buffer_load_dwordx4 v[204:207], v48, s[88:91], s87 offen nt
    s_add_u32 s87, s87, 196608
    buffer_load_dwordx4 v[208:211], v48, s[88:91], s87 offen nt
    s_add_u32 s87, s87, 196608
    buffer_load_dwordx4 v[212:215], v48, s[88:91], s87 offen nt
    s_add_u32 s87, s87, 196608
    buffer_load_dwordx4 v[216:219], v48, s[88:91], s87 offen nt
    s_add_u32 s87, s87, 196608
    buffer_load_dwordx4 v[220:223], v48, s[88:91], s87 offen nt
    s_add_u32 s87, s87, 196608
    buffer_load_dwordx4 v[224:227], v48, s[88:91], s87 offen nt
    s_add_u32 s87, s87, 196608
    buffer_load_dwordx4 v[228:231], v48, s[88:91], s87 offen nt
    s_add_u32 s87, s87, 196608
L_re_23:
    s_branch L_qrdy_21
L_gat_20:
    s_lshl_b32 s32, s28, 14
    s_add_u32 s32, s32, 1048576
    s_add_u32 s33, s32, 4096
    s_add_u32 s34, s32, 8192
    s_add_u32 s35, s32, 12288
    v_lshlrev_b32 v42, 3, v1
    v_add_u32 v43, 0, v1
    v_mul_u32_u24 v44, 2731, v43
    v_lshrrev_b32 v44, 16, v44
    v_mul_u32_u24 v45, 24, v44
    v_sub_u32 v45, v43, v45
    v_lshrrev_b32 v46, 3, v45
    v_and_b32 v45, 7, v45
    v_lshlrev_b32 v46, 6, v46
    v_lshl_add_u32 v46, v44, 3, v46
    v_add_lshl_u32 v48, v46, v45, 1
    v_add_u32 v43, 64, v1
    v_mul_u32_u24 v44, 2731, v43
    v_lshrrev_b32 v44, 16, v44
    v_mul_u32_u24 v45, 24, v44
    v_sub_u32 v45, v43, v45
    v_lshrrev_b32 v46, 3, v45
    v_and_b32 v45, 7, v45
    v_lshlrev_b32 v46, 6, v46
    v_lshl_add_u32 v46, v44, 3, v46
    v_add_lshl_u32 v49, v46, v45, 1
    v_add_u32 v43, 128, v1
    v_mul_u32_u24 v44, 2731, v43
    v_lshrrev_b32 v44, 16, v44
    v_mul_u32_u24 v45, 24, v44
    v_sub_u32 v45, v43, v45
    v_lshrrev_b32 v46, 3, v45
    v_and_b32 v45, 7, v45
    v_lshlrev_b32 v46, 6, v46
    v_lshl_add_u32 v46, v44, 3, v46
    v_add_lshl_u32 v50, v46, v45, 1
    s_mov_b32 s66, 0
L_qspin_24:
    buffer_load_dwordx2 v[64:65], v42, s[16:19], s32 offen offset:0 sc1
    buffer_load_dwordx2 v[66:67], v42, s[16:19], s32 offen offset:512 sc1
    buffer_load_dwordx2 v[68:69], v42, s[16:19], s32 offen offset:1024 sc1
    buffer_load_dwordx2 v[70:71], v42, s[16:19], s32 offen offset:2048 sc1
    buffer_load_dwordx2 v[72:73], v42, s[16:19], s32 offen offset:2560 sc1
    buffer_load_dwordx2 v[74:75], v42, s[16:19], s32 offen offset:3072 sc1
    buffer_load_dwordx2 v[76:77], v42, s[16:19], s33 offen offset:0 sc1
    buffer_load_dwordx2 v[78:79], v42, s[16:19], s33 offen offset:512 sc1
    buffer_load_dwordx2 v[80:81], v42, s[16:19], s33 offen offset:1024 sc1
    buffer_load_dwordx2 v[82:83], v42, s[16:19], s33 offen offset:2048 sc1
    buffer_load_dwordx2 v[84:85], v42, s[16:19], s33 offen offset:2560 sc1
    buffer_load_dwordx2 v[86:87], v42, s[16:19], s33 offen offset:3072 sc1
    buffer_load_dwordx2 v[88:89], v42, s[16:19], s34 offen offset:0 sc1
    buffer_load_dwordx2 v[90:91], v42, s[16:19], s34 offen offset:512 sc1
    buffer_load_dwordx2 v[92:93], v42, s[16:19], s34 offen offset:1024 sc1
    buffer_load_dwordx2 v[94:95], v42, s[16:19], s34 offen offset:2048 sc1
    buffer_load_dwordx2 v[96:97], v42, s[16:19], s34 offen offset:2560 sc1
    buffer_load_dwordx2 v[98:99], v42, s[16:19], s34 offen offset:3072 sc1
    buffer_load_dwordx2 v[100:101], v42, s[16:19], s35 offen offset:0 sc1
    buffer_load_dwordx2 v[102:103], v42, s[16:19], s35 offen offset:512 sc1
    buffer_load_dwordx2 v[104:105], v42, s[16:19], s35 offen offset:1024 sc1
    buffer_load_dwordx2 v[106:107], v42, s[16:19], s35 offen offset:2048 sc1
    buffer_load_dwordx2 v[108:109], v42, s[16:19], s35 offen offset:2560 sc1
    buffer_load_dwordx2 v[110:111], v42, s[16:19], s35 offen offset:3072 sc1
    s_waitcnt vmcnt(0)
    v_min3_u32 v44, v65, v67, v69
    v_max3_u32 v45, v65, v67, v69
    v_min3_u32 v44, v44, v71, v73
    v_max3_u32 v45, v45, v71, v73
    v_min3_u32 v44, v44, v75, v77
    v_max3_u32 v45, v45, v75, v77
    v_min3_u32 v44, v44, v79, v81
    v_max3_u32 v45, v45, v79, v81
    v_min3_u32 v44, v44, v83, v85
    v_max3_u32 v45, v45, v83, v85
    v_min3_u32 v44, v44, v87, v89
    v_max3_u32 v45, v45, v87, v89
    v_min3_u32 v44, v44, v91, v93
    v_max3_u32 v45, v45, v91, v93
    v_min3_u32 v44, v44, v95, v97
    v_max3_u32 v45, v45, v95, v97
    v_min3_u32 v44, v44, v99, v101
    v_max3_u32 v45, v45, v99, v101
    v_min3_u32 v44, v44, v103, v105
    v_max3_u32 v45, v45, v103, v105
    v_min3_u32 v44, v44, v107, v109
    v_max3_u32 v45, v45, v107, v109
    v_min_u32 v44, v44, v111
    v_max_u32 v45, v45, v111
    v_xor_b32 v44, s77, v44
    v_xor_b32 v45, s77, v45
    v_or_b32 v44, v44, v45
    v_cmp_ne_u32 vcc, 0, v44
    s_cbranch_vccz L_qok_25
    s_add_u32 s66, s66, 1
    s_cmp_lt_u32 s66, 200000
    s_cbranch_scc1 L_qspin_24
L_qok_25:
    v_add_f32 v64, v64, v70
    v_add_f32 v64, v64, v76
    v_add_f32 v64, v64, v82
    v_add_f32 v64, v64, v88
    v_add_f32 v64, v64, v94
    v_add_f32 v64, v64, v100
    v_add_f32 v64, v64, v106
    v_cvt_pk_bf16_f32 v64, v64, v64
    ds_write_b16 v48, v64 offset:34880
    v_add_f32 v66, v66, v72
    v_add_f32 v66, v66, v78
    v_add_f32 v66, v66, v84
    v_add_f32 v66, v66, v90
    v_add_f32 v66, v66, v96
    v_add_f32 v66, v66, v102
    v_add_f32 v66, v66, v108
    v_cvt_pk_bf16_f32 v66, v66, v66
    ds_write_b16 v49, v66 offset:34880
    v_add_f32 v68, v68, v74
    v_add_f32 v68, v68, v80
    v_add_f32 v68, v68, v86
    v_add_f32 v68, v68, v92
    v_add_f32 v68, v68, v98
    v_add_f32 v68, v68, v104
    v_add_f32 v68, v68, v110
    v_cvt_pk_bf16_f32 v68, v68, v68
    ds_write_b16 v50, v68 offset:34880
L_qjoin_26:
    v_mov_b32 v42, s77
    s_lshl_b32 s32, s2, 2
    s_add_u32 s32, s32, 966656
    s_mov_b64 exec, 1
    buffer_store_dword v42, v3, s[16:19], s32 offen sc1
    s_mov_b64 exec, -1
    s_cmp_ge_u32 s2, 160
    s_cbranch_scc1 L_rm_27
    s_mov_b32 s88, s44
    s_and_b32 s89, s45, 0xffff
    s_mov_b32 s90, 7864320
    s_mov_b32 s91, 0x20000
    s_and_b32 s32, s2, 7
    s_mul_i32 s32, s32, 768
    s_mul_i32 s33, s3, 192
    s_add_u32 s32, s32, s33
    s_mul_i32 s32, s32, 1280
    s_lshr_b32 s33, s2, 3
    s_lshl_b32 s33, s33, 6
    s_add_u32 s87, s32, s33
    v_lshrrev_b32 v48, 2, v1
    v_mul_u32_u24 v48, 1280, v48
    v_and_b32 v49, 3, v1
    v_lshl_add_u32 v48, v49, 4, v48
    buffer_load_dwordx4 v[192:195], v48, s[88:91], s87 offen nt
    s_add_u32 s87, s87, 20480
    buffer_load_dwordx4 v[196:199], v48, s[88:91], s87 offen nt
    s_add_u32 s87, s87, 20480
    buffer_load_dwordx4 v[200:203], v48, s[88:91], s87 offen nt
    s_add_u32 s87, s87, 20480
    buffer_load_dwordx4 v[204:207], v48, s[88:91], s87 offen nt
    s_add_u32 s87, s87, 20480
    buffer_load_dwordx4 v[208:211], v48, s[88:91], s87 offen nt
    s_add_u32 s87, s87, 20480
    buffer_load_dwordx4 v[212:215], v48, s[88:91], s87 offen nt
    s_add_u32 s87, s87, 20480
    buffer_load_dwordx4 v[216:219], v48, s[88:91], s87 offen nt
    s_add_u32 s87, s87, 20480
    buffer_load_dwordx4 v[220:223], v48, s[88:91], s87 offen nt
    s_add_u32 s87, s87, 20480
    buffer_load_dwordx4 v[224:227], v48, s[88:91], s87 offen nt
    s_add_u32 s87, s87, 20480
    buffer_load_dwordx4 v[228:231], v48, s[88:91], s87 offen nt
    s_add_u32 s87, s87, 20480
    buffer_load_dwordx4 v[232:235], v48, s[88:91], s87 offen nt
    s_add_u32 s87, s87, 20480
    buffer_load_dwordx4 v[236:239], v48, s[88:91], s87 offen nt
    s_add_u32 s87, s87, 20480
    s_branch L_re_28
L_rm_27:
    s_cmp_ge_u32 s3, 2
    s_cselect_b32 s32, s52, s50
    s_cselect_b32 s33, s53, s51
    s_mov_b32 s88, s32
    s_and_b32 s89, s33, 0xffff
    s_mov_b32 s90, 1966080
    s_mov_b32 s91, 0x20000
    s_mov_b32 s92, s54
    s_and_b32 s93, s55, 0xffff
    s_mov_b32 s94, 1966080
    s_mov_b32 s95, 0x20000
    v_and_b32 v49, 127, v0
    v_lshrrev_b32 v48, 1, v49
    v_mul_u32_u24 v48, 3072, v48
    v_and_b32 v49, 1, v49
    v_lshl_add_u32 v48, v49, 4, v48
    s_lshl_b32 s87, s67, 5
    v_mul_u32_u24 v49, 205, v0
    v_lshrrev_b32 v49, 14, v49
    v_mul_u32_u24 v50, 80, v49
    v_sub_u32 v50, v0, v50
    v_mul_u32_u24 v49, 1280, v49
    v_lshl_add_u32 v49, v50, 4, v49
    s_mul_i32 s100, s67, 20480
    buffer_load_dwordx4 v[192:195], v48, s[88:91], s87 offen nt
    s_add_u32 s87, s87, 196608
    buffer_load_dwordx4 v[196:199], v48, s[88:91], s87 offen nt
    s_add_u32 s87, s87, 196608
    buffer_load_dwordx4 v[200:203], v48, s[88:91], s87 offen nt
    s_add_u32 s87, s87, 196608
    buffer_load_dwordx4 v[204:207], v48, s[88:91], s87 offen nt
    s_add_u32 s87, s87, 196608
    buffer_load_dwordx4 v[208:211], v48, s[88:91], s87 offen nt
    s_add_u32 s87, s87, 196608
    buffer_load_dwordx4 v[212:215], v48, s[88:91], s87 offen nt
    s_add_u32 s87, s87, 196608
    buffer_load_dwordx4 v[216:219], v48, s[88:91], s87 offen nt
    s_add_u32 s87, s87, 196608
    buffer_load_dwordx4 v[220:223], v48, s[88:91], s87 offen nt
    s_add_u32 s87, s87, 196608
    buffer_load_dwordx4 v[224:227], v48, s[88:91], s87 offen nt
    s_add_u32 s87, s87, 196608
    buffer_load_dwordx4 v[228:231], v48, s[88:91], s87 offen nt
    s_add_u32 s87, s87, 196608
    buffer_load_dwordx4 v[232:235], v49, s[92:95], s100 offen nt
    s_add_u32 s100, s100, 3840
    buffer_load_dwordx4 v[236:239], v49, s[92:95], s100 offen nt
    s_add_u32 s100, s100, 3840
    buffer_load_dwordx4 v[240:243], v49, s[92:95], s100 offen nt
    s_add_u32 s100, s100, 3840
    buffer_load_dwordx4 v[244:247], v49, s[92:95], s100 offen nt
    s_add_u32 s100, s100, 3840
    buffer_load_dwordx4 v[248:251], v49, s[92:95], s100 offen nt
    s_add_u32 s100, s100, 3840
    buffer_load_dwordx4 v[252:255], v49, s[92:95], s100 offen nt
    s_add_u32 s100, s100, 3840
L_re_28:
L_qrdy_21:
    s_waitcnt lgkmcnt(0)
    s_barrier
    v_and_b32 v42, 7, v1
    v_lshlrev_b32 v42, 4, v42
    ds_read_b128 v[4:7], v42 offset:34880
    ds_read_b128 v[8:11], v42 offset:35008
    ds_read_b128 v[12:15], v42 offset:35136
    v_lshrrev_b32 v188, 3, v1
    v_lshlrev_b32 v188, 3, v188
    s_lshl_b32 s32, s3, 12
    v_add_u32 v189, s32, v188
    s_mov_b32 s74, 0x01010101
    s_mov_b32 s75, 0x01010101
    s_lshl_b32 s72, s78, 6
    s_mov_b32 s65, s79
    s_add_u32 s79, s79, 32
    s_add_u32 s78, s78, 1
    s_add_u32 s62, s65, s76
    s_and_b32 s62, s62, 2047
    s_mul_i32 s62, s62, 6144
    s_add_u32 s62, s62, s63
    buffer_load_dwordx4 v[64:67], v2, s[8:11], s62 offen offset:0 nt
    buffer_load_dwordx4 v[68:71], v2, s[8:11], s62 offen offset:128 nt
    buffer_load_dwordx4 v[72:75], v2, s[8:11], s62 offen offset:256 nt
    buffer_load_dwordx4 v[76:79], v2, s[8:11], s62 offen offset:3072 nt
    buffer_load_dwordx4 v[80:83], v2, s[8:11], s62 offen offset:3200 nt
    buffer_load_dwordx4 v[84:87], v2, s[8:11], s62 offen offset:3328 nt
    v_and_b32 v190, 7, v1
    v_mul_u32_u24 v190, 96, v190
    v_bfe_u32 v50, v1, 4, 1
    v_mul_u32_u24 v50, 48, v50
    v_add_u32 v190, v190, v50
    v_lshrrev_b32 v50, 5, v1
    v_mul_u32_u24 v50, 24, v50
    s_mul_i32 s32, s3, 768
    v_add3_u32 v190, v190, v50, s32
    v_lshlrev_b32 v191, 2, v0
    s_lshl_b32 s5, s86, 10
    s_add_u32 s5, s5, 327680
    s_waitcnt lgkmcnt(0)
    s_mov_b32 s65, s79
    s_add_u32 s79, s79, 32
    s_add_u32 s62, s65, s76
    s_and_b32 s62, s62, 2047
    s_mul_i32 s62, s62, 6144
    s_add_u32 s62, s62, s63
    s_cmp_ge_u32 s78, 59
L_kloop_29:
    s_waitcnt vmcnt(0)
    s_cbranch_scc1 L_kdyn_30
    buffer_load_dwordx4 v[88:91], v2, s[8:11], s62 offen offset:0 nt
    buffer_load_dwordx4 v[92:95], v2, s[8:11], s62 offen offset:128 nt
    buffer_load_dwordx4 v[96:99], v2, s[8:11], s62 offen offset:256 nt
    buffer_load_dwordx4 v[100:103], v2, s[8:11], s62 offen offset:3072 nt
    buffer_load_dwordx4 v[104:107], v2, s[8:11], s62 offen offset:3200 nt
    buffer_load_dwordx4 v[108:111], v2, s[8:11], s62 offen offset:3328 nt
    s_lshl_b32 s73, s78, 6
    s_sub_u32 s32, s65, 1824
    s_lshl_b32 s32, s32, 6
    s_add_u32 s32, s32, s71
    s_cmp_ge_u32 s78, 57
    s_cselect_b32 s73, s32, s73
    s_add_u32 s78, s78, 1
    s_cmp_eq_u32 s78, 59
    s_cbranch_scc1 L_ksw_33
L_kcont_31:
    v_dot2_f32_bf16 v42, v64, v4, 0
    v_dot2_f32_bf16 v44, v68, v8, 0
    v_dot2_f32_bf16 v45, v72, v12, 0
    v_dot2_f32_bf16 v43, v76, v4, 0
    v_dot2_f32_bf16 v46, v80, v8, 0
    v_dot2_f32_bf16 v47, v84, v12, 0
    v_dot2_f32_bf16 v42, v65, v5, v42
    v_dot2_f32_bf16 v44, v69, v9, v44
    v_dot2_f32_bf16 v45, v73, v13, v45
    v_dot2_f32_bf16 v43, v77, v5, v43
    v_dot2_f32_bf16 v46, v81, v9, v46
    v_dot2_f32_bf16 v47, v85, v13, v47
    v_dot2_f32_bf16 v42, v66, v6, v42
    v_dot2_f32_bf16 v44, v70, v10, v44
    v_dot2_f32_bf16 v45, v74, v14, v45
    v_dot2_f32_bf16 v43, v78, v6, v43
    v_dot2_f32_bf16 v46, v82, v10, v46
    v_dot2_f32_bf16 v47, v86, v14, v47
    v_dot2_f32_bf16 v42, v67, v7, v42
    v_dot2_f32_bf16 v44, v71, v11, v44
    v_dot2_f32_bf16 v45, v75, v15, v45
    v_dot2_f32_bf16 v43, v79, v7, v43
    v_dot2_f32_bf16 v46, v83, v11, v46
    v_dot2_f32_bf16 v47, v87, v15, v47
    s_nop 1
    v_add_f32 v42, v42, v44
    v_add_f32 v43, v43, v46
    v_add_f32 v42, v42, v45
    v_add_f32 v43, v43, v47
    s_nop 0
    v_add_f32_dpp v42, v42, v42 quad_perm:[1,0,3,2] row_mask:0xf bank_mask:0xf
    v_add_f32_dpp v43, v43, v43 quad_perm:[1,0,3,2] row_mask:0xf bank_mask:0xf
    s_nop 0
    v_add_f32_dpp v42, v42, v42 quad_perm:[2,3,0,1] row_mask:0xf bank_mask:0xf
    v_add_f32_dpp v43, v43, v43 quad_perm:[2,3,0,1] row_mask:0xf bank_mask:0xf
    s_nop 0
    v_add_f32_dpp v42, v42, v42 row_half_mirror row_mask:0xf bank_mask:0xf
    v_add_f32_dpp v43, v43, v43 row_half_mirror row_mask:0xf bank_mask:0xf
    v_cvt_pk_bf16_f32 v44, v42, v43
    v_lshlrev_b32 v42, 16, v44
    v_and_b32 v43, 0xffff0000, v44
    v_mul_f32 v42, s30, v42
    v_mul_f32 v43, s30, v43
    v_cvt_pk_bf16_f32 v44, v42, v43
    v_lshlrev_b32 v42, 16, v44
    v_and_b32 v43, 0xffff0000, v44
    s_cmp_lt_i32 s72, 0
    s_mov_b64 exec, s[74:75]
    s_cbranch_scc1 L_kd_34
    v_add_u32 v44, s72, v189
    ds_write_b64 v44, v[42:43] offset:38912
    s_branch L_kj_35
L_kd_34:
    s_and_b32 s32, s72, 0x7fffffff
    buffer_store_dwordx2 v[42:43], v188, s[16:19], s32 offen sc1
L_kj_35:
    s_mov_b64 exec, -1
    s_mov_b32 s65, s79
    s_add_u32 s79, s79, 32
    s_add_u32 s62, s65, s76
    s_and_b32 s62, s62, 2047
    s_mul_i32 s62, s62, 6144
    s_add_u32 s62, s62, s63
    s_cmp_ge_u32 s78, 59
    s_branch L_kn_36
L_kdyn_30:
    v_readfirstlane_b32 s65, v56
    s_nop 0
    s_cmp_ge_u32 s65, 160
    s_cbranch_scc1 L_kdrain_32
    s_add_u32 s65, s65, 1888
    s_sub_u32 s32, s65, 1824
    s_lshl_b32 s32, s32, 6
    s_add_u32 s73, s32, s71
    s_add_u32 s62, s65, s76
    s_and_b32 s62, s62, 2047
    s_mul_i32 s62, s62, 6144
    s_add_u32 s62, s62, s63
    buffer_load_dwordx4 v[88:91], v2, s[8:11], s62 offen offset:0 nt
    buffer_load_dwordx4 v[92:95], v2, s[8:11], s62 offen offset:128 nt
    buffer_load_dwordx4 v[96:99], v2, s[8:11], s62 offen offset:256 nt
    buffer_load_dwordx4 v[100:103], v2, s[8:11], s62 offen offset:3072 nt
    buffer_load_dwordx4 v[104:107], v2, s[8:11], s62 offen offset:3200 nt
    buffer_load_dwordx4 v[108:111], v2, s[8:11], s62 offen offset:3328 nt
    v_mov_b32 v56, 1
    s_mov_b64 exec, 1
    buffer_atomic_add v56, v3, s[16:19], s64 offen sc0
    s_mov_b64 exec, -1
    s_branch L_kcont_31
L_kn_36:
    s_waitcnt vmcnt(0)
    s_cbranch_scc1 L_kdyn_37
    buffer_load_dwordx4 v[64:67], v2, s[8:11], s62 offen offset:0 nt
    buffer_load_dwordx4 v[68:71], v2, s[8:11], s62 offen offset:128 nt
    buffer_load_dwordx4 v[72:75], v2, s[8:11], s62 offen offset:256 nt
    buffer_load_dwordx4 v[76:79], v2, s[8:11], s62 offen offset:3072 nt
    buffer_load_dwordx4 v[80:83], v2, s[8:11], s62 offen offset:3200 nt
    buffer_load_dwordx4 v[84:87], v2, s[8:11], s62 offen offset:3328 nt
    s_lshl_b32 s72, s78, 6
    s_sub_u32 s32, s65, 1824
    s_lshl_b32 s32, s32, 6
    s_add_u32 s32, s32, s71
    s_cmp_ge_u32 s78, 57
    s_cselect_b32 s72, s32, s72
    s_add_u32 s78, s78, 1
    s_cmp_eq_u32 s78, 59
    s_cbranch_scc1 L_ksw_40
L_kcont_38:
    v_dot2_f32_bf16 v42, v88, v4, 0
    v_dot2_f32_bf16 v44, v92, v8, 0
    v_dot2_f32_bf16 v45, v96, v12, 0
    v_dot2_f32_bf16 v43, v100, v4, 0
    v_dot2_f32_bf16 v46, v104, v8, 0
    v_dot2_f32_bf16 v47, v108, v12, 0
    v_dot2_f32_bf16 v42, v89, v5, v42
    v_dot2_f32_bf16 v44, v93, v9, v44
    v_dot2_f32_bf16 v45, v97, v13, v45
    v_dot2_f32_bf16 v43, v101, v5, v43
    v_dot2_f32_bf16 v46, v105, v9, v46
    v_dot2_f32_bf16 v47, v109, v13, v47
    v_dot2_f32_bf16 v42, v90, v6, v42
    v_dot2_f32_bf16 v44, v94, v10, v44
    v_dot2_f32_bf16 v45, v98, v14, v45
    v_dot2_f32_bf16 v43, v102, v6, v43
    v_dot2_f32_bf16 v46, v106, v10, v46
    v_dot2_f32_bf16 v47, v110, v14, v47
    v_dot2_f32_bf16 v42, v91, v7, v42
    v_dot2_f32_bf16 v44, v95, v11, v44
    v_dot2_f32_bf16 v45, v99, v15, v45
    v_dot2_f32_bf16 v43, v103, v7, v43
    v_dot2_f32_bf16 v46, v107, v11, v46
    v_dot2_f32_bf16 v47, v111, v15, v47
    s_nop 1
    v_add_f32 v42, v42, v44
    v_add_f32 v43, v43, v46
    v_add_f32 v42, v42, v45
    v_add_f32 v43, v43, v47
    s_nop 0
    v_add_f32_dpp v42, v42, v42 quad_perm:[1,0,3,2] row_mask:0xf bank_mask:0xf
    v_add_f32_dpp v43, v43, v43 quad_perm:[1,0,3,2] row_mask:0xf bank_mask:0xf
    s_nop 0
    v_add_f32_dpp v42, v42, v42 quad_perm:[2,3,0,1] row_mask:0xf bank_mask:0xf
    v_add_f32_dpp v43, v43, v43 quad_perm:[2,3,0,1] row_mask:0xf bank_mask:0xf
    s_nop 0
    v_add_f32_dpp v42, v42, v42 row_half_mirror row_mask:0xf bank_mask:0xf
    v_add_f32_dpp v43, v43, v43 row_half_mirror row_mask:0xf bank_mask:0xf
    v_cvt_pk_bf16_f32 v44, v42, v43
    v_lshlrev_b32 v42, 16, v44
    v_and_b32 v43, 0xffff0000, v44
    v_mul_f32 v42, s30, v42
    v_mul_f32 v43, s30, v43
    v_cvt_pk_bf16_f32 v44, v42, v43
    v_lshlrev_b32 v42, 16, v44
    v_and_b32 v43, 0xffff0000, v44
    s_cmp_lt_i32 s73, 0
    s_mov_b64 exec, s[74:75]
    s_cbranch_scc1 L_kd_41
    v_add_u32 v44, s73, v189
    ds_write_b64 v44, v[42:43] offset:38912
    s_branch L_kj_42
L_kd_41:
    s_and_b32 s32, s73, 0x7fffffff
    buffer_store_dwordx2 v[42:43], v188, s[16:19], s32 offen sc1
L_kj_42:
    s_mov_b64 exec, -1
    s_mov_b32 s65, s79
    s_add_u32 s79, s79, 32
    s_add_u32 s62, s65, s76
    s_and_b32 s62, s62, 2047
    s_mul_i32 s62, s62, 6144
    s_add_u32 s62, s62, s63
    s_cmp_ge_u32 s78, 59
    s_branch L_kloop_29
L_kdyn_37:
    v_readfirstlane_b32 s65, v56
    s_nop 0
    s_cmp_ge_u32 s65, 160
    s_cbranch_scc1 L_kdrain_39
    s_add_u32 s65, s65, 1888
    s_sub_u32 s32, s65, 1824
    s_lshl_b32 s32, s32, 6
    s_add_u32 s72, s32, s71
    s_add_u32 s62, s65, s76
    s_and_b32 s62, s62, 2047
    s_mul_i32 s62, s62, 6144
    s_add_u32 s62, s62, s63
    buffer_load_dwordx4 v[64:67], v2, s[8:11], s62 offen offset:0 nt
    buffer_load_dwordx4 v[68:71], v2, s[8:11], s62 offen offset:128 nt
    buffer_load_dwordx4 v[72:75], v2, s[8:11], s62 offen offset:256 nt
    buffer_load_dwordx4 v[76:79], v2, s[8:11], s62 offen offset:3072 nt
    buffer_load_dwordx4 v[80:83], v2, s[8:11], s62 offen offset:3200 nt
    buffer_load_dwordx4 v[84:87], v2, s[8:11], s62 offen offset:3328 nt
    v_mov_b32 v56, 1
    s_mov_b64 exec, 1
    buffer_atomic_add v56, v3, s[16:19], s64 offen sc0
    s_mov_b64 exec, -1
    s_branch L_kcont_38
L_ksw_33:
    v_mov_b32 v56, 1
    s_mov_b64 exec, 1
    buffer_atomic_add v56, v3, s[16:19], s64 offen sc0
    s_mov_b64 exec, -1
    v_lshlrev_b32 v50, 4, v1
    s_mov_b32 s32, 966656
    buffer_load_dwordx4 v[172:175], v50, s[16:19], s32 offen sc1
    s_branch L_kcont_31
L_ksw_40:
    v_mov_b32 v56, 1
    s_mov_b64 exec, 1
    buffer_atomic_add v56, v3, s[16:19], s64 offen sc0
    s_mov_b64 exec, -1
    v_lshlrev_b32 v50, 4, v1
    s_mov_b32 s32, 966656
    buffer_load_dwordx4 v[172:175], v50, s[16:19], s32 offen sc1
    s_branch L_kcont_38
L_kdrain_32:
    s_lshl_b32 s79, s29, 2
    s_add_u32 s79, s79, s3
    s_mov_b32 s78, 0
    s_add_u32 s64, s64, 128
    s_mov_b32 s65, s79
    s_add_u32 s79, s79, 32
    s_add_u32 s78, s78, 1
    s_add_u32 s62, s65, s76
    s_and_b32 s62, s62, 2047
    s_mul_i32 s62, s62, 6144
    s_add_u32 s62, s62, s63
    buffer_load_dwordx4 v[88:91], v2, s[12:15], s62 offen offset:0 nt
    buffer_load_dwordx4 v[92:95], v2, s[12:15], s62 offen offset:128 nt
    buffer_load_dwordx4 v[96:99], v2, s[12:15], s62 offen offset:256 nt
    buffer_load_dwordx4 v[100:103], v2, s[12:15], s62 offen offset:3072 nt
    buffer_load_dwordx4 v[104:107], v2, s[12:15], s62 offen offset:3200 nt
    buffer_load_dwordx4 v[108:111], v2, s[12:15], s62 offen offset:3328 nt
    v_dot2_f32_bf16 v42, v64, v4, 0
    v_dot2_f32_bf16 v44, v68, v8, 0
    v_dot2_f32_bf16 v45, v72, v12, 0
    v_dot2_f32_bf16 v43, v76, v4, 0
    v_dot2_f32_bf16 v46, v80, v8, 0
    v_dot2_f32_bf16 v47, v84, v12, 0
    v_dot2_f32_bf16 v42, v65, v5, v42
    v_dot2_f32_bf16 v44, v69, v9, v44
    v_dot2_f32_bf16 v45, v73, v13, v45
    v_dot2_f32_bf16 v43, v77, v5, v43
    v_dot2_f32_bf16 v46, v81, v9, v46
    v_dot2_f32_bf16 v47, v85, v13, v47
    v_dot2_f32_bf16 v42, v66, v6, v42
    v_dot2_f32_bf16 v44, v70, v10, v44
    v_dot2_f32_bf16 v45, v74, v14, v45
    v_dot2_f32_bf16 v43, v78, v6, v43
    v_dot2_f32_bf16 v46, v82, v10, v46
    v_dot2_f32_bf16 v47, v86, v14, v47
    v_dot2_f32_bf16 v42, v67, v7, v42
    v_dot2_f32_bf16 v44, v71, v11, v44
    v_dot2_f32_bf16 v45, v75, v15, v45
    v_dot2_f32_bf16 v43, v79, v7, v43
    v_dot2_f32_bf16 v46, v83, v11, v46
    v_dot2_f32_bf16 v47, v87, v15, v47
    s_nop 1
    v_add_f32 v42, v42, v44
    v_add_f32 v43, v43, v46
    v_add_f32 v42, v42, v45
    v_add_f32 v43, v43, v47
    s_nop 0
    v_add_f32_dpp v42, v42, v42 quad_perm:[1,0,3,2] row_mask:0xf bank_mask:0xf
    v_add_f32_dpp v43, v43, v43 quad_perm:[1,0,3,2] row_mask:0xf bank_mask:0xf
    s_nop 0
    v_add_f32_dpp v42, v42, v42 quad_perm:[2,3,0,1] row_mask:0xf bank_mask:0xf
    v_add_f32_dpp v43, v43, v43 quad_perm:[2,3,0,1] row_mask:0xf bank_mask:0xf
    s_nop 0
    v_add_f32_dpp v42, v42, v42 row_half_mirror row_mask:0xf bank_mask:0xf
    v_add_f32_dpp v43, v43, v43 row_half_mirror row_mask:0xf bank_mask:0xf
    v_cvt_pk_bf16_f32 v44, v42, v43
    v_lshlrev_b32 v42, 16, v44
    v_and_b32 v43, 0xffff0000, v44
    v_mul_f32 v42, s30, v42
    v_mul_f32 v43, s30, v43
    v_cvt_pk_bf16_f32 v44, v42, v43
    v_lshlrev_b32 v42, 16, v44
    v_and_b32 v43, 0xffff0000, v44
    s_cmp_lt_i32 s72, 0
    s_mov_b64 exec, s[74:75]
    s_cbranch_scc1 L_kd_45
    v_add_u32 v44, s72, v189
    ds_write_b64 v44, v[42:43] offset:38912
    s_branch L_kj_46
L_kd_45:
    s_and_b32 s32, s72, 0x7fffffff
    buffer_store_dwordx2 v[42:43], v188, s[16:19], s32 offen sc1
L_kj_46:
    s_mov_b64 exec, -1
    v_min_u32 v42, v172, v173
    v_min3_u32 v42, v42, v174, v175
    v_max_u32 v43, v172, v173
    v_max3_u32 v43, v43, v174, v175
    v_xor_b32 v42, s77, v42
    v_xor_b32 v43, s77, v43
    v_or_b32 v42, v42, v43
    v_cmp_ne_u32 vcc, 0, v42
    s_cbranch_vccz L_dok_47
    s_mov_b32 s66, 0
L_dlp_48:
    v_lshlrev_b32 v50, 4, v1
    s_mov_b32 s32, 966656
    buffer_load_dwordx4 v[172:175], v50, s[16:19], s32 offen sc1
    s_waitcnt vmcnt(0)
    v_min_u32 v42, v172, v173
    v_min3_u32 v42, v42, v174, v175
    v_max_u32 v43, v172, v173
    v_max3_u32 v43, v43, v174, v175
    v_xor_b32 v42, s77, v42
    v_xor_b32 v43, s77, v43
    v_or_b32 v42, v42, v43
    v_cmp_ne_u32 vcc, 0, v42
    s_cbranch_vccz L_dok_47
    s_add_u32 s66, s66, 1
    s_cmp_lt_u32 s66, 200000
    s_cbranch_scc1 L_dlp_48
L_dok_47:
    s_or_b32 s32, s2, s3
    s_cmp_lg_u32 s32, 0
    s_cbranch_scc1 L_ep_49
    v_mov_b32 v42, s77
    s_mov_b32 s32, 950272
    s_mov_b64 exec, 1
    buffer_store_dword v42, v3, s[16:19], s32 offen sc1
    s_mov_b64 exec, -1
L_ep_49:
    v_mov_b32 v16, 0
    v_mov_b32 v17, 0
    v_mov_b32 v18, 0
    v_mov_b32 v19, 0
    v_mov_b32 v20, 0
    v_mov_b32 v21, 0
    v_mov_b32 v22, 0
    v_mov_b32 v23, 0
    v_mov_b32 v24, 0
    v_mov_b32 v25, 0
    v_mov_b32 v26, 0
    v_mov_b32 v27, 0
    v_mov_b32 v28, 0
    v_mov_b32 v29, 0
    v_mov_b32 v30, 0
    v_mov_b32 v31, 0
    v_mov_b32 v32, 0
    v_mov_b32 v33, 0
    v_mov_b32 v34, 0
    v_mov_b32 v35, 0
    v_mov_b32 v36, 0
    v_mov_b32 v37, 0
    v_mov_b32 v38, 0
    v_mov_b32 v39, 0
    v_mov_b32 v40, 0xff61b1e6
    v_mov_b32 v41, 0
    s_waitcnt lgkmcnt(0)
    ds_read_b64 v[114:115], v189 offset:38912
    s_mov_b32 s65, s79
    s_add_u32 s79, s79, 32
    s_add_u32 s62, s65, s76
    s_and_b32 s62, s62, 2047
    s_mul_i32 s62, s62, 6144
    s_add_u32 s62, s62, s63
    s_cmp_ge_u32 s78, 57
    s_branch L_vent1_44
L_kdrain_39:
    s_lshl_b32 s79, s29, 2
    s_add_u32 s79, s79, s3
    s_mov_b32 s78, 0
    s_add_u32 s64, s64, 128
    s_mov_b32 s65, s79
    s_add_u32 s79, s79, 32
    s_add_u32 s78, s78, 1
    s_add_u32 s62, s65, s76
    s_and_b32 s62, s62, 2047
    s_mul_i32 s62, s62, 6144
    s_add_u32 s62, s62, s63
    buffer_load_dwordx4 v[64:67], v2, s[12:15], s62 offen offset:0 nt
    buffer_load_dwordx4 v[68:71], v2, s[12:15], s62 offen offset:128 nt
    buffer_load_dwordx4 v[72:75], v2, s[12:15], s62 offen offset:256 nt
    buffer_load_dwordx4 v[76:79], v2, s[12:15], s62 offen offset:3072 nt
    buffer_load_dwordx4 v[80:83], v2, s[12:15], s62 offen offset:3200 nt
    buffer_load_dwordx4 v[84:87], v2, s[12:15], s62 offen offset:3328 nt
    v_dot2_f32_bf16 v42, v88, v4, 0
    v_dot2_f32_bf16 v44, v92, v8, 0
    v_dot2_f32_bf16 v45, v96, v12, 0
    v_dot2_f32_bf16 v43, v100, v4, 0
    v_dot2_f32_bf16 v46, v104, v8, 0
    v_dot2_f32_bf16 v47, v108, v12, 0
    v_dot2_f32_bf16 v42, v89, v5, v42
    v_dot2_f32_bf16 v44, v93, v9, v44
    v_dot2_f32_bf16 v45, v97, v13, v45
    v_dot2_f32_bf16 v43, v101, v5, v43
    v_dot2_f32_bf16 v46, v105, v9, v46
    v_dot2_f32_bf16 v47, v109, v13, v47
    v_dot2_f32_bf16 v42, v90, v6, v42
    v_dot2_f32_bf16 v44, v94, v10, v44
    v_dot2_f32_bf16 v45, v98, v14, v45
    v_dot2_f32_bf16 v43, v102, v6, v43
    v_dot2_f32_bf16 v46, v106, v10, v46
    v_dot2_f32_bf16 v47, v110, v14, v47
    v_dot2_f32_bf16 v42, v91, v7, v42
    v_dot2_f32_bf16 v44, v95, v11, v44
    v_dot2_f32_bf16 v45, v99, v15, v45
    v_dot2_f32_bf16 v43, v103, v7, v43
    v_dot2_f32_bf16 v46, v107, v11, v46
    v_dot2_f32_bf16 v47, v111, v15, v47
    s_nop 1
    v_add_f32 v42, v42, v44
    v_add_f32 v43, v43, v46
    v_add_f32 v42, v42, v45
    v_add_f32 v43, v43, v47
    s_nop 0
    v_add_f32_dpp v42, v42, v42 quad_perm:[1,0,3,2] row_mask:0xf bank_mask:0xf
    v_add_f32_dpp v43, v43, v43 quad_perm:[1,0,3,2] row_mask:0xf bank_mask:0xf
    s_nop 0
    v_add_f32_dpp v42, v42, v42 quad_perm:[2,3,0,1] row_mask:0xf bank_mask:0xf
    v_add_f32_dpp v43, v43, v43 quad_perm:[2,3,0,1] row_mask:0xf bank_mask:0xf
    s_nop 0
    v_add_f32_dpp v42, v42, v42 row_half_mirror row_mask:0xf bank_mask:0xf
    v_add_f32_dpp v43, v43, v43 row_half_mirror row_mask:0xf bank_mask:0xf
    v_cvt_pk_bf16_f32 v44, v42, v43
    v_lshlrev_b32 v42, 16, v44
    v_and_b32 v43, 0xffff0000, v44
    v_mul_f32 v42, s30, v42
    v_mul_f32 v43, s30, v43
    v_cvt_pk_bf16_f32 v44, v42, v43
    v_lshlrev_b32 v42, 16, v44
    v_and_b32 v43, 0xffff0000, v44
    s_cmp_lt_i32 s73, 0
    s_mov_b64 exec, s[74:75]
    s_cbranch_scc1 L_kd_50
    v_add_u32 v44, s73, v189
    ds_write_b64 v44, v[42:43] offset:38912
    s_branch L_kj_51
L_kd_50:
    s_and_b32 s32, s73, 0x7fffffff
    buffer_store_dwordx2 v[42:43], v188, s[16:19], s32 offen sc1
L_kj_51:
    s_mov_b64 exec, -1
    v_min_u32 v42, v172, v173
    v_min3_u32 v42, v42, v174, v175
    v_max_u32 v43, v172, v173
    v_max3_u32 v43, v43, v174, v175
    v_xor_b32 v42, s77, v42
    v_xor_b32 v43, s77, v43
    v_or_b32 v42, v42, v43
    v_cmp_ne_u32 vcc, 0, v42
    s_cbranch_vccz L_dok_52
    s_mov_b32 s66, 0
L_dlp_53:
    v_lshlrev_b32 v50, 4, v1
    s_mov_b32 s32, 966656
    buffer_load_dwordx4 v[172:175], v50, s[16:19], s32 offen sc1
    s_waitcnt vmcnt(0)
    v_min_u32 v42, v172, v173
    v_min3_u32 v42, v42, v174, v175
    v_max_u32 v43, v172, v173
    v_max3_u32 v43, v43, v174, v175
    v_xor_b32 v42, s77, v42
    v_xor_b32 v43, s77, v43
    v_or_b32 v42, v42, v43
    v_cmp_ne_u32 vcc, 0, v42
    s_cbranch_vccz L_dok_52
    s_add_u32 s66, s66, 1
    s_cmp_lt_u32 s66, 200000
    s_cbranch_scc1 L_dlp_53
L_dok_52:
    s_or_b32 s32, s2, s3
    s_cmp_lg_u32 s32, 0
    s_cbranch_scc1 L_ep_54
    v_mov_b32 v42, s77
    s_mov_b32 s32, 950272
    s_mov_b64 exec, 1
    buffer_store_dword v42, v3, s[16:19], s32 offen sc1
    s_mov_b64 exec, -1
L_ep_54:
    v_mov_b32 v16, 0
    v_mov_b32 v17, 0
    v_mov_b32 v18, 0
    v_mov_b32 v19, 0
    v_mov_b32 v20, 0
    v_mov_b32 v21, 0
    v_mov_b32 v22, 0
    v_mov_b32 v23, 0
    v_mov_b32 v24, 0
    v_mov_b32 v25, 0
    v_mov_b32 v26, 0
    v_mov_b32 v27, 0
    v_mov_b32 v28, 0
    v_mov_b32 v29, 0
    v_mov_b32 v30, 0
    v_mov_b32 v31, 0
    v_mov_b32 v32, 0
    v_mov_b32 v33, 0
    v_mov_b32 v34, 0
    v_mov_b32 v35, 0
    v_mov_b32 v36, 0
    v_mov_b32 v37, 0
    v_mov_b32 v38, 0
    v_mov_b32 v39, 0
    v_mov_b32 v40, 0xff61b1e6
    v_mov_b32 v41, 0
    s_waitcnt lgkmcnt(0)
    ds_read_b64 v[112:113], v189 offset:38912
    s_mov_b32 s65, s79
    s_add_u32 s79, s79, 32
    s_add_u32 s62, s65, s76
    s_and_b32 s62, s62, 2047
    s_mul_i32 s62, s62, 6144
    s_add_u32 s62, s62, s63
    s_cmp_ge_u32 s78, 57
    s_branch L_vent0_43
L_vent0_43:
    s_waitcnt vmcnt(0) lgkmcnt(0)
    s_cbranch_scc1 L_vdyn_56
    buffer_load_dwordx4 v[88:91], v2, s[12:15], s62 offen offset:0 nt
    buffer_load_dwordx4 v[92:95], v2, s[12:15], s62 offen offset:128 nt
    buffer_load_dwordx4 v[96:99], v2, s[12:15], s62 offen offset:256 nt
    buffer_load_dwordx4 v[100:103], v2, s[12:15], s62 offen offset:3072 nt
    buffer_load_dwordx4 v[104:107], v2, s[12:15], s62 offen offset:3200 nt
    buffer_load_dwordx4 v[108:111], v2, s[12:15], s62 offen offset:3328 nt
    s_lshl_b32 s32, s78, 6
    v_add_u32 v42, s32, v189
    ds_read_b64 v[114:115], v42 offset:38912
    s_add_u32 s78, s78, 1
    s_cmp_eq_u32 s78, 57
    s_cbranch_scc1 L_vsw_59
L_vcont_57:
    v_max_u32 v42, v112, v113
    v_cmp_eq_u32 vcc, -1, v42
    s_cbranch_vccnz L_vrp_60
L_vrb_61:
    v_max3_f32 v42, v40, v112, v113
    v_sub_f32 v44, v40, v42
    v_sub_f32 v45, v112, v42
    v_sub_f32 v46, v113, v42
    v_mul_f32 v44, s31, v44
    v_mul_f32 v45, s31, v45
    v_mul_f32 v46, s31, v46
    v_exp_f32 v44, v44
    v_exp_f32 v45, v45
    v_exp_f32 v46, v46
    v_mov_b32 v40, v42
    v_fma_f32 v41, v41, v44, v45
    v_cvt_pk_bf16_f32 v42, v45, 0
    v_cvt_pk_bf16_f32 v43, 0, v45
    v_add_f32 v41, v41, v46
    v_cvt_pk_bf16_f32 v47, v46, 0
    v_cvt_pk_bf16_f32 v46, 0, v46
    v_pk_mul_f32 v[16:17], v[16:17], v[44:45] op_sel_hi:[1,0]
    v_pk_mul_f32 v[18:19], v[18:19], v[44:45] op_sel_hi:[1,0]
    v_pk_mul_f32 v[20:21], v[20:21], v[44:45] op_sel_hi:[1,0]
    v_pk_mul_f32 v[22:23], v[22:23], v[44:45] op_sel_hi:[1,0]
    v_pk_mul_f32 v[24:25], v[24:25], v[44:45] op_sel_hi:[1,0]
    v_pk_mul_f32 v[26:27], v[26:27], v[44:45] op_sel_hi:[1,0]
    v_pk_mul_f32 v[28:29], v[28:29], v[44:45] op_sel_hi:[1,0]
    v_pk_mul_f32 v[30:31], v[30:31], v[44:45] op_sel_hi:[1,0]
    v_pk_mul_f32 v[32:33], v[32:33], v[44:45] op_sel_hi:[1,0]
    v_pk_mul_f32 v[34:35], v[34:35], v[44:45] op_sel_hi:[1,0]
    v_pk_mul_f32 v[36:37], v[36:37], v[44:45] op_sel_hi:[1,0]
    v_pk_mul_f32 v[38:39], v[38:39], v[44:45] op_sel_hi:[1,0]
    v_dot2_f32_bf16 v16, v64, v42, v16
    v_dot2_f32_bf16 v17, v64, v43, v17
    v_dot2_f32_bf16 v18, v65, v42, v18
    v_dot2_f32_bf16 v19, v65, v43, v19
    v_dot2_f32_bf16 v20, v66, v42, v20
    v_dot2_f32_bf16 v21, v66, v43, v21
    v_dot2_f32_bf16 v22, v67, v42, v22
    v_dot2_f32_bf16 v23, v67, v43, v23
    v_dot2_f32_bf16 v24, v68, v42, v24
    v_dot2_f32_bf16 v25, v68, v43, v25
    v_dot2_f32_bf16 v26, v69, v42, v26
    v_dot2_f32_bf16 v27, v69, v43, v27
    v_dot2_f32_bf16 v28, v70, v42, v28
    v_dot2_f32_bf16 v29, v70, v43, v29
    v_dot2_f32_bf16 v30, v71, v42, v30
    v_dot2_f32_bf16 v31, v71, v43, v31
    v_dot2_f32_bf16 v32, v72, v42, v32
    v_dot2_f32_bf16 v33, v72, v43, v33
    v_dot2_f32_bf16 v34, v73, v42, v34
    v_dot2_f32_bf16 v35, v73, v43, v35
    v_dot2_f32_bf16 v36, v74, v42, v36
    v_dot2_f32_bf16 v37, v74, v43, v37
    v_dot2_f32_bf16 v38, v75, v42, v38
    v_dot2_f32_bf16 v39, v75, v43, v39
    v_dot2_f32_bf16 v16, v76, v47, v16
    v_dot2_f32_bf16 v17, v76, v46, v17
    v_dot2_f32_bf16 v18, v77, v47, v18
    v_dot2_f32_bf16 v19, v77, v46, v19
    v_dot2_f32_bf16 v20, v78, v47, v20
    v_dot2_f32_bf16 v21, v78, v46, v21
    v_dot2_f32_bf16 v22, v79, v47, v22
    v_dot2_f32_bf16 v23, v79, v46, v23
    v_dot2_f32_bf16 v24, v80, v47, v24
    v_dot2_f32_bf16 v25, v80, v46, v25
    v_dot2_f32_bf16 v26, v81, v47, v26
    v_dot2_f32_bf16 v27, v81, v46, v27
    v_dot2_f32_bf16 v28, v82, v47, v28
    v_dot2_f32_bf16 v29, v82, v46, v29
    v_dot2_f32_bf16 v30, v83, v47, v30
    v_dot2_f32_bf16 v31, v83, v46, v31
    v_dot2_f32_bf16 v32, v84, v47, v32
    v_dot2_f32_bf16 v33, v84, v46, v33
    v_dot2_f32_bf16 v34, v85, v47, v34
    v_dot2_f32_bf16 v35, v85, v46, v35
    v_dot2_f32_bf16 v36, v86, v47, v36
    v_dot2_f32_bf16 v37, v86, v46, v37
    v_dot2_f32_bf16 v38, v87, v47, v38
    v_dot2_f32_bf16 v39, v87, v46, v39
    s_mov_b32 s65, s79
    s_add_u32 s79, s79, 32
    s_add_u32 s62, s65, s76
    s_and_b32 s62, s62, 2047
    s_mul_i32 s62, s62, 6144
    s_add_u32 s62, s62, s63
    s_cmp_ge_u32 s78, 57
    s_branch L_vent1_44
L_vdyn_56:
    v_readfirstlane_b32 s65, v56
    s_nop 0
    s_cmp_ge_u32 s65, 224
    s_cbranch_scc1 L_vdrain_58
    s_lshl_b32 s73, s65, 6
    s_add_u32 s73, s73, s69
    s_add_u32 s65, s65, 1824
    s_add_u32 s62, s65, s76
    s_and_b32 s62, s62, 2047
    s_mul_i32 s62, s62, 6144
    s_add_u32 s62, s62, s63
    buffer_load_dwordx4 v[88:91], v2, s[12:15], s62 offen offset:0 nt
    buffer_load_dwordx4 v[92:95], v2, s[12:15], s62 offen offset:128 nt
    buffer_load_dwordx4 v[96:99], v2, s[12:15], s62 offen offset:256 nt
    buffer_load_dwordx4 v[100:103], v2, s[12:15], s62 offen offset:3072 nt
    buffer_load_dwordx4 v[104:107], v2, s[12:15], s62 offen offset:3200 nt
    buffer_load_dwordx4 v[108:111], v2, s[12:15], s62 offen offset:3328 nt
    buffer_load_dwordx2 v[114:115], v188, s[16:19], s73 offen sc1
    v_mov_b32 v56, 1
    s_mov_b64 exec, 1
    buffer_atomic_add v56, v3, s[16:19], s64 offen sc0
    s_mov_b64 exec, -1
    s_branch L_vcont_57
L_vent1_44:
    s_waitcnt vmcnt(0) lgkmcnt(0)
    s_cbranch_scc1 L_vdyn_62
    buffer_load_dwordx4 v[64:67], v2, s[12:15], s62 offen offset:0 nt
    buffer_load_dwordx4 v[68:71], v2, s[12:15], s62 offen offset:128 nt
    buffer_load_dwordx4 v[72:75], v2, s[12:15], s62 offen offset:256 nt
    buffer_load_dwordx4 v[76:79], v2, s[12:15], s62 offen offset:3072 nt
    buffer_load_dwordx4 v[80:83], v2, s[12:15], s62 offen offset:3200 nt
    buffer_load_dwordx4 v[84:87], v2, s[12:15], s62 offen offset:3328 nt
    s_lshl_b32 s32, s78, 6
    v_add_u32 v42, s32, v189
    ds_read_b64 v[112:113], v42 offset:38912
    s_add_u32 s78, s78, 1
    s_cmp_eq_u32 s78, 57
    s_cbranch_scc1 L_vsw_65
L_vcont_63:
    v_max_u32 v42, v114, v115
    v_cmp_eq_u32 vcc, -1, v42
    s_cbranch_vccnz L_vrp_66
L_vrb_67:
    v_max3_f32 v42, v40, v114, v115
    v_sub_f32 v44, v40, v42
    v_sub_f32 v45, v114, v42
    v_sub_f32 v46, v115, v42
    v_mul_f32 v44, s31, v44
    v_mul_f32 v45, s31, v45
    v_mul_f32 v46, s31, v46
    v_exp_f32 v44, v44
    v_exp_f32 v45, v45
    v_exp_f32 v46, v46
    v_mov_b32 v40, v42
    v_fma_f32 v41, v41, v44, v45
    v_cvt_pk_bf16_f32 v42, v45, 0
    v_cvt_pk_bf16_f32 v43, 0, v45
    v_add_f32 v41, v41, v46
    v_cvt_pk_bf16_f32 v47, v46, 0
    v_cvt_pk_bf16_f32 v46, 0, v46
    v_pk_mul_f32 v[16:17], v[16:17], v[44:45] op_sel_hi:[1,0]
    v_pk_mul_f32 v[18:19], v[18:19], v[44:45] op_sel_hi:[1,0]
    v_pk_mul_f32 v[20:21], v[20:21], v[44:45] op_sel_hi:[1,0]
    v_pk_mul_f32 v[22:23], v[22:23], v[44:45] op_sel_hi:[1,0]
    v_pk_mul_f32 v[24:25], v[24:25], v[44:45] op_sel_hi:[1,0]
    v_pk_mul_f32 v[26:27], v[26:27], v[44:45] op_sel_hi:[1,0]
    v_pk_mul_f32 v[28:29], v[28:29], v[44:45] op_sel_hi:[1,0]
    v_pk_mul_f32 v[30:31], v[30:31], v[44:45] op_sel_hi:[1,0]
    v_pk_mul_f32 v[32:33], v[32:33], v[44:45] op_sel_hi:[1,0]
    v_pk_mul_f32 v[34:35], v[34:35], v[44:45] op_sel_hi:[1,0]
    v_pk_mul_f32 v[36:37], v[36:37], v[44:45] op_sel_hi:[1,0]
    v_pk_mul_f32 v[38:39], v[38:39], v[44:45] op_sel_hi:[1,0]
    v_dot2_f32_bf16 v16, v88, v42, v16
    v_dot2_f32_bf16 v17, v88, v43, v17
    v_dot2_f32_bf16 v18, v89, v42, v18
    v_dot2_f32_bf16 v19, v89, v43, v19
    v_dot2_f32_bf16 v20, v90, v42, v20
    v_dot2_f32_bf16 v21, v90, v43, v21
    v_dot2_f32_bf16 v22, v91, v42, v22
    v_dot2_f32_bf16 v23, v91, v43, v23
    v_dot2_f32_bf16 v24, v92, v42, v24
    v_dot2_f32_bf16 v25, v92, v43, v25
    v_dot2_f32_bf16 v26, v93, v42, v26
    v_dot2_f32_bf16 v27, v93, v43, v27
    v_dot2_f32_bf16 v28, v94, v42, v28
    v_dot2_f32_bf16 v29, v94, v43, v29
    v_dot2_f32_bf16 v30, v95, v42, v30
    v_dot2_f32_bf16 v31, v95, v43, v31
    v_dot2_f32_bf16 v32, v96, v42, v32
    v_dot2_f32_bf16 v33, v96, v43, v33
    v_dot2_f32_bf16 v34, v97, v42, v34
    v_dot2_f32_bf16 v35, v97, v43, v35
    v_dot2_f32_bf16 v36, v98, v42, v36
    v_dot2_f32_bf16 v37, v98, v43, v37
    v_dot2_f32_bf16 v38, v99, v42, v38
    v_dot2_f32_bf16 v39, v99, v43, v39
    v_dot2_f32_bf16 v16, v100, v47, v16
    v_dot2_f32_bf16 v17, v100, v46, v17
    v_dot2_f32_bf16 v18, v101, v47, v18
    v_dot2_f32_bf16 v19, v101, v46, v19
    v_dot2_f32_bf16 v20, v102, v47, v20
    v_dot2_f32_bf16 v21, v102, v46, v21
    v_dot2_f32_bf16 v22, v103, v47, v22
    v_dot2_f32_bf16 v23, v103, v46, v23
    v_dot2_f32_bf16 v24, v104, v47, v24
    v_dot2_f32_bf16 v25, v104, v46, v25
    v_dot2_f32_bf16 v26, v105, v47, v26
    v_dot2_f32_bf16 v27, v105, v46, v27
    v_dot2_f32_bf16 v28, v106, v47, v28
    v_dot2_f32_bf16 v29, v106, v46, v29
    v_dot2_f32_bf16 v30, v107, v47, v30
    v_dot2_f32_bf16 v31, v107, v46, v31
    v_dot2_f32_bf16 v32, v108, v47, v32
    v_dot2_f32_bf16 v33, v108, v46, v33
    v_dot2_f32_bf16 v34, v109, v47, v34
    v_dot2_f32_bf16 v35, v109, v46, v35
    v_dot2_f32_bf16 v36, v110, v47, v36
    v_dot2_f32_bf16 v37, v110, v46, v37
    v_dot2_f32_bf16 v38, v111, v47, v38
    v_dot2_f32_bf16 v39, v111, v46, v39
    s_mov_b32 s65, s79
    s_add_u32 s79, s79, 32
    s_add_u32 s62, s65, s76
    s_and_b32 s62, s62, 2047
    s_mul_i32 s62, s62, 6144
    s_add_u32 s62, s62, s63
    s_cmp_ge_u32 s78, 57
    s_branch L_vent0_43
L_vdyn_62:
    v_readfirstlane_b32 s65, v56
    s_nop 0
    s_cmp_ge_u32 s65, 224
    s_cbranch_scc1 L_vdrain_64
    s_lshl_b32 s72, s65, 6
    s_add_u32 s72, s72, s69
    s_add_u32 s65, s65, 1824
    s_add_u32 s62, s65, s76
    s_and_b32 s62, s62, 2047
    s_mul_i32 s62, s62, 6144
    s_add_u32 s62, s62, s63
    buffer_load_dwordx4 v[64:67], v2, s[12:15], s62 offen offset:0 nt
    buffer_load_dwordx4 v[68:71], v2, s[12:15], s62 offen offset:128 nt
    buffer_load_dwordx4 v[72:75], v2, s[12:15], s62 offen offset:256 nt
    buffer_load_dwordx4 v[76:79], v2, s[12:15], s62 offen offset:3072 nt
    buffer_load_dwordx4 v[80:83], v2, s[12:15], s62 offen offset:3200 nt
    buffer_load_dwordx4 v[84:87], v2, s[12:15], s62 offen offset:3328 nt
    buffer_load_dwordx2 v[112:113], v188, s[16:19], s72 offen sc1
    v_mov_b32 v56, 1
    s_mov_b64 exec, 1
    buffer_atomic_add v56, v3, s[16:19], s64 offen sc0
    s_mov_b64 exec, -1
    s_branch L_vcont_63
L_vsw_59:
    v_mov_b32 v56, 1
    s_mov_b64 exec, 1
    buffer_atomic_add v56, v3, s[16:19], s64 offen sc0
    s_mov_b64 exec, -1
    s_mov_b32 s34, 0x05040100
    s_mov_b32 s35, 0x07060302
    s_cmp_ge_u32 s2, 160
    s_cbranch_scc1 L_rm_68
    v_perm_b32 v50, v196, v192, s35
    v_perm_b32 v192, v196, v192, s34
    v_mov_b32 v196, v50
    v_perm_b32 v50, v197, v193, s35
    v_perm_b32 v193, v197, v193, s34
    v_mov_b32 v197, v50
    v_perm_b32 v50, v198, v194, s35
    v_perm_b32 v194, v198, v194, s34
    v_mov_b32 v198, v50
    v_perm_b32 v50, v199, v195, s35
    v_perm_b32 v195, v199, v195, s34
    v_mov_b32 v199, v50
    v_perm_b32 v50, v204, v200, s35
    v_perm_b32 v200, v204, v200, s34
    v_mov_b32 v204, v50
    v_perm_b32 v50, v205, v201, s35
    v_perm_b32 v201, v205, v201, s34
    v_mov_b32 v205, v50
    v_perm_b32 v50, v206, v202, s35
    v_perm_b32 v202, v206, v202, s34
    v_mov_b32 v206, v50
    v_perm_b32 v50, v207, v203, s35
    v_perm_b32 v203, v207, v203, s34
    v_mov_b32 v207, v50
    v_perm_b32 v50, v212, v208, s35
    v_perm_b32 v208, v212, v208, s34
    v_mov_b32 v212, v50
    v_perm_b32 v50, v213, v209, s35
    v_perm_b32 v209, v213, v209, s34
    v_mov_b32 v213, v50
    v_perm_b32 v50, v214, v210, s35
    v_perm_b32 v210, v214, v210, s34
    v_mov_b32 v214, v50
    v_perm_b32 v50, v215, v211, s35
    v_perm_b32 v211, v215, v211, s34
    v_mov_b32 v215, v50
    v_perm_b32 v50, v220, v216, s35
    v_perm_b32 v216, v220, v216, s34
    v_mov_b32 v220, v50
    v_perm_b32 v50, v221, v217, s35
    v_perm_b32 v217, v221, v217, s34
    v_mov_b32 v221, v50
    v_perm_b32 v50, v222, v218, s35
    v_perm_b32 v218, v222, v218, s34
    v_mov_b32 v222, v50
    v_perm_b32 v50, v223, v219, s35
    v_perm_b32 v219, v223, v219, s34
    v_mov_b32 v223, v50
    v_perm_b32 v50, v228, v224, s35
    v_perm_b32 v224, v228, v224, s34
    v_mov_b32 v228, v50
    v_perm_b32 v50, v229, v225, s35
    v_perm_b32 v225, v229, v225, s34
    v_mov_b32 v229, v50
    v_perm_b32 v50, v230, v226, s35
    v_perm_b32 v226, v230, v226, s34
    v_mov_b32 v230, v50
    v_perm_b32 v50, v231, v227, s35
    v_perm_b32 v227, v231, v227, s34
    v_mov_b32 v231, v50
    v_perm_b32 v50, v236, v232, s35
    v_perm_b32 v232, v236, v232, s34
    v_mov_b32 v236, v50
    v_perm_b32 v50, v237, v233, s35
    v_perm_b32 v233, v237, v233, s34
    v_mov_b32 v237, v50
    v_perm_b32 v50, v238, v234, s35
    v_perm_b32 v234, v238, v234, s34
    v_mov_b32 v238, v50
    v_perm_b32 v50, v239, v235, s35
    v_perm_b32 v235, v239, v235, s34
    v_mov_b32 v239, v50
    s_branch L_re_69
L_rm_68:
    v_perm_b32 v50, v196, v192, s35
    v_perm_b32 v192, v196, v192, s34
    v_mov_b32 v196, v50
    v_perm_b32 v50, v197, v193, s35
    v_perm_b32 v193, v197, v193, s34
    v_mov_b32 v197, v50
    v_perm_b32 v50, v198, v194, s35
    v_perm_b32 v194, v198, v194, s34
    v_mov_b32 v198, v50
    v_perm_b32 v50, v199, v195, s35
    v_perm_b32 v195, v199, v195, s34
    v_mov_b32 v199, v50
    v_perm_b32 v50, v204, v200, s35
    v_perm_b32 v200, v204, v200, s34
    v_mov_b32 v204, v50
    v_perm_b32 v50, v205, v201, s35
    v_perm_b32 v201, v205, v201, s34
    v_mov_b32 v205, v50
    v_perm_b32 v50, v206, v202, s35
    v_perm_b32 v202, v206, v202, s34
    v_mov_b32 v206, v50
    v_perm_b32 v50, v207, v203, s35
    v_perm_b32 v203, v207, v203, s34
    v_mov_b32 v207, v50
    v_perm_b32 v50, v212, v208, s35
    v_perm_b32 v208, v212, v208, s34
    v_mov_b32 v212, v50
    v_perm_b32 v50, v213, v209, s35
    v_perm_b32 v209, v213, v209, s34
    v_mov_b32 v213, v50
    v_perm_b32 v50, v214, v210, s35
    v_perm_b32 v210, v214, v210, s34
    v_mov_b32 v214, v50
    v_perm_b32 v50, v215, v211, s35
    v_perm_b32 v211, v215, v211, s34
    v_mov_b32 v215, v50
    v_perm_b32 v50, v220, v216, s35
    v_perm_b32 v216, v220, v216, s34
    v_mov_b32 v220, v50
    v_perm_b32 v50, v221, v217, s35
    v_perm_b32 v217, v221, v217, s34
    v_mov_b32 v221, v50
    v_perm_b32 v50, v222, v218, s35
    v_perm_b32 v218, v222, v218, s34
    v_mov_b32 v222, v50
    v_perm_b32 v50, v223, v219, s35
    v_perm_b32 v219, v223, v219, s34
    v_mov_b32 v223, v50
    v_perm_b32 v50, v228, v224, s35
    v_perm_b32 v224, v228, v224, s34
    v_mov_b32 v228, v50
    v_perm_b32 v50, v229, v225, s35
    v_perm_b32 v225, v229, v225, s34
    v_mov_b32 v229, v50
    v_perm_b32 v50, v230, v226, s35
    v_perm_b32 v226, v230, v226, s34
    v_mov_b32 v230, v50
    v_perm_b32 v50, v231, v227, s35
    v_perm_b32 v227, v231, v227, s34
    v_mov_b32 v231, v50
    v_perm_b32 v50, v236, v232, s35
    v_perm_b32 v232, v236, v232, s34
    v_mov_b32 v236, v50
    v_perm_b32 v50, v237, v233, s35
    v_perm_b32 v233, v237, v233, s34
    v_mov_b32 v237, v50
    v_perm_b32 v50, v238, v234, s35
    v_perm_b32 v234, v238, v234, s34
    v_mov_b32 v238, v50
    v_perm_b32 v50, v239, v235, s35
    v_perm_b32 v235, v239, v235, s34
    v_mov_b32 v239, v50
    v_perm_b32 v50, v244, v240, s35
    v_perm_b32 v240, v244, v240, s34
    v_mov_b32 v244, v50
    v_perm_b32 v50, v245, v241, s35
    v_perm_b32 v241, v245, v241, s34
    v_mov_b32 v245, v50
    v_perm_b32 v50, v246, v242, s35
    v_perm_b32 v242, v246, v242, s34
    v_mov_b32 v246, v50
    v_perm_b32 v50, v247, v243, s35
    v_perm_b32 v243, v247, v243, s34
    v_mov_b32 v247, v50
    v_perm_b32 v50, v252, v248, s35
    v_perm_b32 v248, v252, v248, s34
    v_mov_b32 v252, v50
    v_perm_b32 v50, v253, v249, s35
    v_perm_b32 v249, v253, v249, s34
    v_mov_b32 v253, v50
    v_perm_b32 v50, v254, v250, s35
    v_perm_b32 v250, v254, v250, s34
    v_mov_b32 v254, v50
    v_perm_b32 v50, v255, v251, s35
    v_perm_b32 v251, v255, v251, s34
    v_mov_b32 v255, v50
L_re_69:
    s_cmp_lt_u32 s2, 160
    s_cbranch_scc1 L_lx_70
    s_mov_b32 s92, s36
    s_and_b32 s93, s37, 0xffff
    s_mov_b32 s94, 1280
    s_mov_b32 s95, 0x20000
    s_mov_b32 s96, s48
    s_and_b32 s97, s49, 0xffff
    s_mov_b32 s98, 1280
    s_mov_b32 s99, 0x20000
    v_lshlrev_b32 v50, 3, v1
    s_mul_i32 s32, s3, 320
    buffer_load_dwordx2 v[176:177], v50, s[92:95], s32 offen
    v_lshlrev_b32 v50, 2, v1
    buffer_load_dword v181, v50, s[96:99], 0 offen offset:0
    buffer_load_dword v182, v50, s[96:99], 0 offen offset:256
    buffer_load_dword v183, v50, s[96:99], 0 offen offset:512
    buffer_load_dword v184, v50, s[96:99], 0 offen offset:768
    buffer_load_dword v185, v50, s[96:99], 0 offen offset:1024
L_lx_70:
    s_getpc_b64 s[88:89]
L_pc_71:
    s_add_u32 s88, s88, L_tail_start-L_pc_71
    s_addc_u32 s89, s89, 0
    s_and_b32 s89, s89, 0xffff
    s_mov_b32 s90, L_code_end-L_tail_start
    s_mov_b32 s91, 0x20000
    s_lshr_b32 s32, s2, 3
    s_mul_i32 s32, s32, (((L_code_end-L_tail_start)+31)/32+15)&0xfffffff0
    v_lshlrev_b32 v50, 4, v1
    buffer_load_dwordx4 v[52:55], v50, s[88:91], s32 offen offset:0
    s_branch L_vcont_57
L_vsw_65:
    v_mov_b32 v56, 1
    s_mov_b64 exec, 1
    buffer_atomic_add v56, v3, s[16:19], s64 offen sc0
    s_mov_b64 exec, -1
    s_mov_b32 s34, 0x05040100
    s_mov_b32 s35, 0x07060302
    s_cmp_ge_u32 s2, 160
    s_cbranch_scc1 L_rm_72
    v_perm_b32 v50, v196, v192, s35
    v_perm_b32 v192, v196, v192, s34
    v_mov_b32 v196, v50
    v_perm_b32 v50, v197, v193, s35
    v_perm_b32 v193, v197, v193, s34
    v_mov_b32 v197, v50
    v_perm_b32 v50, v198, v194, s35
    v_perm_b32 v194, v198, v194, s34
    v_mov_b32 v198, v50
    v_perm_b32 v50, v199, v195, s35
    v_perm_b32 v195, v199, v195, s34
    v_mov_b32 v199, v50
    v_perm_b32 v50, v204, v200, s35
    v_perm_b32 v200, v204, v200, s34
    v_mov_b32 v204, v50
    v_perm_b32 v50, v205, v201, s35
    v_perm_b32 v201, v205, v201, s34
    v_mov_b32 v205, v50
    v_perm_b32 v50, v206, v202, s35
    v_perm_b32 v202, v206, v202, s34
    v_mov_b32 v206, v50
    v_perm_b32 v50, v207, v203, s35
    v_perm_b32 v203, v207, v203, s34
    v_mov_b32 v207, v50
    v_perm_b32 v50, v212, v208, s35
    v_perm_b32 v208, v212, v208, s34
    v_mov_b32 v212, v50
    v_perm_b32 v50, v213, v209, s35
    v_perm_b32 v209, v213, v209, s34
    v_mov_b32 v213, v50
    v_perm_b32 v50, v214, v210, s35
    v_perm_b32 v210, v214, v210, s34
    v_mov_b32 v214, v50
    v_perm_b32 v50, v215, v211, s35
    v_perm_b32 v211, v215, v211, s34
    v_mov_b32 v215, v50
    v_perm_b32 v50, v220, v216, s35
    v_perm_b32 v216, v220, v216, s34
    v_mov_b32 v220, v50
    v_perm_b32 v50, v221, v217, s35
    v_perm_b32 v217, v221, v217, s34
    v_mov_b32 v221, v50
    v_perm_b32 v50, v222, v218, s35
    v_perm_b32 v218, v222, v218, s34
    v_mov_b32 v222, v50
    v_perm_b32 v50, v223, v219, s35
    v_perm_b32 v219, v223, v219, s34
    v_mov_b32 v223, v50
    v_perm_b32 v50, v228, v224, s35
    v_perm_b32 v224, v228, v224, s34
    v_mov_b32 v228, v50
    v_perm_b32 v50, v229, v225, s35
    v_perm_b32 v225, v229, v225, s34
    v_mov_b32 v229, v50
    v_perm_b32 v50, v230, v226, s35
    v_perm_b32 v226, v230, v226, s34
    v_mov_b32 v230, v50
    v_perm_b32 v50, v231, v227, s35
    v_perm_b32 v227, v231, v227, s34
    v_mov_b32 v231, v50
    v_perm_b32 v50, v236, v232, s35
    v_perm_b32 v232, v236, v232, s34
    v_mov_b32 v236, v50
    v_perm_b32 v50, v237, v233, s35
    v_perm_b32 v233, v237, v233, s34
    v_mov_b32 v237, v50
    v_perm_b32 v50, v238, v234, s35
    v_perm_b32 v234, v238, v234, s34
    v_mov_b32 v238, v50
    v_perm_b32 v50, v239, v235, s35
    v_perm_b32 v235, v239, v235, s34
    v_mov_b32 v239, v50
    s_branch L_re_73
L_rm_72:
    v_perm_b32 v50, v196, v192, s35
    v_perm_b32 v192, v196, v192, s34
    v_mov_b32 v196, v50
    v_perm_b32 v50, v197, v193, s35
    v_perm_b32 v193, v197, v193, s34
    v_mov_b32 v197, v50
    v_perm_b32 v50, v198, v194, s35
    v_perm_b32 v194, v198, v194, s34
    v_mov_b32 v198, v50
    v_perm_b32 v50, v199, v195, s35
    v_perm_b32 v195, v199, v195, s34
    v_mov_b32 v199, v50
    v_perm_b32 v50, v204, v200, s35
    v_perm_b32 v200, v204, v200, s34
    v_mov_b32 v204, v50
    v_perm_b32 v50, v205, v201, s35
    v_perm_b32 v201, v205, v201, s34
    v_mov_b32 v205, v50
    v_perm_b32 v50, v206, v202, s35
    v_perm_b32 v202, v206, v202, s34
    v_mov_b32 v206, v50
    v_perm_b32 v50, v207, v203, s35
    v_perm_b32 v203, v207, v203, s34
    v_mov_b32 v207, v50
    v_perm_b32 v50, v212, v208, s35
    v_perm_b32 v208, v212, v208, s34
    v_mov_b32 v212, v50
    v_perm_b32 v50, v213, v209, s35
    v_perm_b32 v209, v213, v209, s34
    v_mov_b32 v213, v50
    v_perm_b32 v50, v214, v210, s35
    v_perm_b32 v210, v214, v210, s34
    v_mov_b32 v214, v50
    v_perm_b32 v50, v215, v211, s35
    v_perm_b32 v211, v215, v211, s34
    v_mov_b32 v215, v50
    v_perm_b32 v50, v220, v216, s35
    v_perm_b32 v216, v220, v216, s34
    v_mov_b32 v220, v50
    v_perm_b32 v50, v221, v217, s35
    v_perm_b32 v217, v221, v217, s34
    v_mov_b32 v221, v50
    v_perm_b32 v50, v222, v218, s35
    v_perm_b32 v218, v222, v218, s34
    v_mov_b32 v222, v50
    v_perm_b32 v50, v223, v219, s35
    v_perm_b32 v219, v223, v219, s34
    v_mov_b32 v223, v50
    v_perm_b32 v50, v228, v224, s35
    v_perm_b32 v224, v228, v224, s34
    v_mov_b32 v228, v50
    v_perm_b32 v50, v229, v225, s35
    v_perm_b32 v225, v229, v225, s34
    v_mov_b32 v229, v50
    v_perm_b32 v50, v230, v226, s35
    v_perm_b32 v226, v230, v226, s34
    v_mov_b32 v230, v50
    v_perm_b32 v50, v231, v227, s35
    v_perm_b32 v227, v231, v227, s34
    v_mov_b32 v231, v50
    v_perm_b32 v50, v236, v232, s35
    v_perm_b32 v232, v236, v232, s34
    v_mov_b32 v236, v50
    v_perm_b32 v50, v237, v233, s35
    v_perm_b32 v233, v237, v233, s34
    v_mov_b32 v237, v50
    v_perm_b32 v50, v238, v234, s35
    v_perm_b32 v234, v238, v234, s34
    v_mov_b32 v238, v50
    v_perm_b32 v50, v239, v235, s35
    v_perm_b32 v235, v239, v235, s34
    v_mov_b32 v239, v50
    v_perm_b32 v50, v244, v240, s35
    v_perm_b32 v240, v244, v240, s34
    v_mov_b32 v244, v50
    v_perm_b32 v50, v245, v241, s35
    v_perm_b32 v241, v245, v241, s34
    v_mov_b32 v245, v50
    v_perm_b32 v50, v246, v242, s35
    v_perm_b32 v242, v246, v242, s34
    v_mov_b32 v246, v50
    v_perm_b32 v50, v247, v243, s35
    v_perm_b32 v243, v247, v243, s34
    v_mov_b32 v247, v50
    v_perm_b32 v50, v252, v248, s35
    v_perm_b32 v248, v252, v248, s34
    v_mov_b32 v252, v50
    v_perm_b32 v50, v253, v249, s35
    v_perm_b32 v249, v253, v249, s34
    v_mov_b32 v253, v50
    v_perm_b32 v50, v254, v250, s35
    v_perm_b32 v250, v254, v250, s34
    v_mov_b32 v254, v50
    v_perm_b32 v50, v255, v251, s35
    v_perm_b32 v251, v255, v251, s34
    v_mov_b32 v255, v50
L_re_73:
    s_cmp_lt_u32 s2, 160
    s_cbranch_scc1 L_lx_74
    s_mov_b32 s92, s36
    s_and_b32 s93, s37, 0xffff
    s_mov_b32 s94, 1280
    s_mov_b32 s95, 0x20000
    s_mov_b32 s96, s48
    s_and_b32 s97, s49, 0xffff
    s_mov_b32 s98, 1280
    s_mov_b32 s99, 0x20000
    v_lshlrev_b32 v50, 3, v1
    s_mul_i32 s32, s3, 320
    buffer_load_dwordx2 v[176:177], v50, s[92:95], s32 offen
    v_lshlrev_b32 v50, 2, v1
    buffer_load_dword v181, v50, s[96:99], 0 offen offset:0
    buffer_load_dword v182, v50, s[96:99], 0 offen offset:256
    buffer_load_dword v183, v50, s[96:99], 0 offen offset:512
    buffer_load_dword v184, v50, s[96:99], 0 offen offset:768
    buffer_load_dword v185, v50, s[96:99], 0 offen offset:1024
L_lx_74:
    s_getpc_b64 s[88:89]
L_pc_75:
    s_add_u32 s88, s88, L_tail_start-L_pc_75
    s_addc_u32 s89, s89, 0
    s_and_b32 s89, s89, 0xffff
    s_mov_b32 s90, L_code_end-L_tail_start
    s_mov_b32 s91, 0x20000
    s_lshr_b32 s32, s2, 3
    s_mul_i32 s32, s32, (((L_code_end-L_tail_start)+31)/32+15)&0xfffffff0
    v_lshlrev_b32 v50, 4, v1
    buffer_load_dwordx4 v[52:55], v50, s[88:91], s32 offen offset:0
    s_branch L_vcont_63
L_vrp_60:
    s_mov_b32 s66, 0
L_rpl_76:
    buffer_load_dwordx2 v[112:113], v188, s[16:19], s72 offen sc1
    s_waitcnt vmcnt(0)
    v_max_u32 v42, v112, v113
    v_cmp_eq_u32 vcc, -1, v42
    s_cbranch_vccz L_vrb_61
    s_add_u32 s66, s66, 1
    s_cmp_lt_u32 s66, 200000
    s_cbranch_scc1 L_rpl_76
    s_branch L_vrb_61
L_vrp_66:
    s_mov_b32 s66, 0
L_rpl_77:
    buffer_load_dwordx2 v[114:115], v188, s[16:19], s73 offen sc1
    s_waitcnt vmcnt(0)
    v_max_u32 v42, v114, v115
    v_cmp_eq_u32 vcc, -1, v42
    s_cbranch_vccz L_vrb_67
    s_add_u32 s66, s66, 1
    s_cmp_lt_u32 s66, 200000
    s_cbranch_scc1 L_rpl_77
    s_branch L_vrb_67
L_vdrain_58:
    v_max_u32 v42, v112, v113
    v_cmp_eq_u32 vcc, -1, v42
    s_cbranch_vccz L_drb_79
    s_mov_b32 s66, 0
L_drl_80:
    buffer_load_dwordx2 v[112:113], v188, s[16:19], s72 offen sc1
    s_waitcnt vmcnt(0)
    v_max_u32 v42, v112, v113
    v_cmp_eq_u32 vcc, -1, v42
    s_cbranch_vccz L_drb_79
    s_add_u32 s66, s66, 1
    s_cmp_lt_u32 s66, 200000
    s_cbranch_scc1 L_drl_80
L_drb_79:
    v_max3_f32 v42, v40, v112, v113
    v_sub_f32 v44, v40, v42
    v_sub_f32 v45, v112, v42
    v_sub_f32 v46, v113, v42
    v_mul_f32 v44, s31, v44
    v_mul_f32 v45, s31, v45
    v_mul_f32 v46, s31, v46
    v_exp_f32 v44, v44
    v_exp_f32 v45, v45
    v_exp_f32 v46, v46
    v_mov_b32 v40, v42
    v_fma_f32 v41, v41, v44, v45
    v_cvt_pk_bf16_f32 v42, v45, 0
    v_cvt_pk_bf16_f32 v43, 0, v45
    v_add_f32 v41, v41, v46
    v_cvt_pk_bf16_f32 v47, v46, 0
    v_cvt_pk_bf16_f32 v46, 0, v46
    v_pk_mul_f32 v[16:17], v[16:17], v[44:45] op_sel_hi:[1,0]
    v_pk_mul_f32 v[18:19], v[18:19], v[44:45] op_sel_hi:[1,0]
    v_pk_mul_f32 v[20:21], v[20:21], v[44:45] op_sel_hi:[1,0]
    v_pk_mul_f32 v[22:23], v[22:23], v[44:45] op_sel_hi:[1,0]
    v_pk_mul_f32 v[24:25], v[24:25], v[44:45] op_sel_hi:[1,0]
    v_pk_mul_f32 v[26:27], v[26:27], v[44:45] op_sel_hi:[1,0]
    v_pk_mul_f32 v[28:29], v[28:29], v[44:45] op_sel_hi:[1,0]
    v_pk_mul_f32 v[30:31], v[30:31], v[44:45] op_sel_hi:[1,0]
    v_pk_mul_f32 v[32:33], v[32:33], v[44:45] op_sel_hi:[1,0]
    v_pk_mul_f32 v[34:35], v[34:35], v[44:45] op_sel_hi:[1,0]
    v_pk_mul_f32 v[36:37], v[36:37], v[44:45] op_sel_hi:[1,0]
    v_pk_mul_f32 v[38:39], v[38:39], v[44:45] op_sel_hi:[1,0]
    v_dot2_f32_bf16 v16, v64, v42, v16
    v_dot2_f32_bf16 v17, v64, v43, v17
    v_dot2_f32_bf16 v18, v65, v42, v18
    v_dot2_f32_bf16 v19, v65, v43, v19
    v_dot2_f32_bf16 v20, v66, v42, v20
    v_dot2_f32_bf16 v21, v66, v43, v21
    v_dot2_f32_bf16 v22, v67, v42, v22
    v_dot2_f32_bf16 v23, v67, v43, v23
    v_dot2_f32_bf16 v24, v68, v42, v24
    v_dot2_f32_bf16 v25, v68, v43, v25
    v_dot2_f32_bf16 v26, v69, v42, v26
    v_dot2_f32_bf16 v27, v69, v43, v27
    v_dot2_f32_bf16 v28, v70, v42, v28
    v_dot2_f32_bf16 v29, v70, v43, v29
    v_dot2_f32_bf16 v30, v71, v42, v30
    v_dot2_f32_bf16 v31, v71, v43, v31
    v_dot2_f32_bf16 v32, v72, v42, v32
    v_dot2_f32_bf16 v33, v72, v43, v33
    v_dot2_f32_bf16 v34, v73, v42, v34
    v_dot2_f32_bf16 v35, v73, v43, v35
    v_dot2_f32_bf16 v36, v74, v42, v36
    v_dot2_f32_bf16 v37, v74, v43, v37
    v_dot2_f32_bf16 v38, v75, v42, v38
    v_dot2_f32_bf16 v39, v75, v43, v39
    v_dot2_f32_bf16 v16, v76, v47, v16
    v_dot2_f32_bf16 v17, v76, v46, v17
    v_dot2_f32_bf16 v18, v77, v47, v18
    v_dot2_f32_bf16 v19, v77, v46, v19
    v_dot2_f32_bf16 v20, v78, v47, v20
    v_dot2_f32_bf16 v21, v78, v46, v21
    v_dot2_f32_bf16 v22, v79, v47, v22
    v_dot2_f32_bf16 v23, v79, v46, v23
    v_dot2_f32_bf16 v24, v80, v47, v24
    v_dot2_f32_bf16 v25, v80, v46, v25
    v_dot2_f32_bf16 v26, v81, v47, v26
    v_dot2_f32_bf16 v27, v81, v46, v27
    v_dot2_f32_bf16 v28, v82, v47, v28
    v_dot2_f32_bf16 v29, v82, v46, v29
    v_dot2_f32_bf16 v30, v83, v47, v30
    v_dot2_f32_bf16 v31, v83, v46, v31
    v_dot2_f32_bf16 v32, v84, v47, v32
    v_dot2_f32_bf16 v33, v84, v46, v33
    v_dot2_f32_bf16 v34, v85, v47, v34
    v_dot2_f32_bf16 v35, v85, v46, v35
    v_dot2_f32_bf16 v36, v86, v47, v36
    v_dot2_f32_bf16 v37, v86, v46, v37
    v_dot2_f32_bf16 v38, v87, v47, v38
    v_dot2_f32_bf16 v39, v87, v46, v39
    s_branch L_sdone_55
L_vdrain_64:
    v_max_u32 v42, v114, v115
    v_cmp_eq_u32 vcc, -1, v42
    s_cbranch_vccz L_drb_82
    s_mov_b32 s66, 0
L_drl_83:
    buffer_load_dwordx2 v[114:115], v188, s[16:19], s73 offen sc1
    s_waitcnt vmcnt(0)
    v_max_u32 v42, v114, v115
    v_cmp_eq_u32 vcc, -1, v42
    s_cbranch_vccz L_drb_82
    s_add_u32 s66, s66, 1
    s_cmp_lt_u32 s66, 200000
    s_cbranch_scc1 L_drl_83
L_drb_82:
    v_max3_f32 v42, v40, v114, v115
    v_sub_f32 v44, v40, v42
    v_sub_f32 v45, v114, v42
    v_sub_f32 v46, v115, v42
    v_mul_f32 v44, s31, v44
    v_mul_f32 v45, s31, v45
    v_mul_f32 v46, s31, v46
    v_exp_f32 v44, v44
    v_exp_f32 v45, v45
    v_exp_f32 v46, v46
    v_mov_b32 v40, v42
    v_fma_f32 v41, v41, v44, v45
    v_cvt_pk_bf16_f32 v42, v45, 0
    v_cvt_pk_bf16_f32 v43, 0, v45
    v_add_f32 v41, v41, v46
    v_cvt_pk_bf16_f32 v47, v46, 0
    v_cvt_pk_bf16_f32 v46, 0, v46
    v_pk_mul_f32 v[16:17], v[16:17], v[44:45] op_sel_hi:[1,0]
    v_pk_mul_f32 v[18:19], v[18:19], v[44:45] op_sel_hi:[1,0]
    v_pk_mul_f32 v[20:21], v[20:21], v[44:45] op_sel_hi:[1,0]
    v_pk_mul_f32 v[22:23], v[22:23], v[44:45] op_sel_hi:[1,0]
    v_pk_mul_f32 v[24:25], v[24:25], v[44:45] op_sel_hi:[1,0]
    v_pk_mul_f32 v[26:27], v[26:27], v[44:45] op_sel_hi:[1,0]
    v_pk_mul_f32 v[28:29], v[28:29], v[44:45] op_sel_hi:[1,0]
    v_pk_mul_f32 v[30:31], v[30:31], v[44:45] op_sel_hi:[1,0]
    v_pk_mul_f32 v[32:33], v[32:33], v[44:45] op_sel_hi:[1,0]
    v_pk_mul_f32 v[34:35], v[34:35], v[44:45] op_sel_hi:[1,0]
    v_pk_mul_f32 v[36:37], v[36:37], v[44:45] op_sel_hi:[1,0]
    v_pk_mul_f32 v[38:39], v[38:39], v[44:45] op_sel_hi:[1,0]
    v_dot2_f32_bf16 v16, v88, v42, v16
    v_dot2_f32_bf16 v17, v88, v43, v17
    v_dot2_f32_bf16 v18, v89, v42, v18
    v_dot2_f32_bf16 v19, v89, v43, v19
    v_dot2_f32_bf16 v20, v90, v42, v20
    v_dot2_f32_bf16 v21, v90, v43, v21
    v_dot2_f32_bf16 v22, v91, v42, v22
    v_dot2_f32_bf16 v23, v91, v43, v23
    v_dot2_f32_bf16 v24, v92, v42, v24
    v_dot2_f32_bf16 v25, v92, v43, v25
    v_dot2_f32_bf16 v26, v93, v42, v26
    v_dot2_f32_bf16 v27, v93, v43, v27
    v_dot2_f32_bf16 v28, v94, v42, v28
    v_dot2_f32_bf16 v29, v94, v43, v29
    v_dot2_f32_bf16 v30, v95, v42, v30
    v_dot2_f32_bf16 v31, v95, v43, v31
    v_dot2_f32_bf16 v32, v96, v42, v32
    v_dot2_f32_bf16 v33, v96, v43, v33
    v_dot2_f32_bf16 v34, v97, v42, v34
    v_dot2_f32_bf16 v35, v97, v43, v35
    v_dot2_f32_bf16 v36, v98, v42, v36
    v_dot2_f32_bf16 v37, v98, v43, v37
    v_dot2_f32_bf16 v38, v99, v42, v38
    v_dot2_f32_bf16 v39, v99, v43, v39
    v_dot2_f32_bf16 v16, v100, v47, v16
    v_dot2_f32_bf16 v17, v100, v46, v17
    v_dot2_f32_bf16 v18, v101, v47, v18
    v_dot2_f32_bf16 v19, v101, v46, v19
    v_dot2_f32_bf16 v20, v102, v47, v20
    v_dot2_f32_bf16 v21, v102, v46, v21
    v_dot2_f32_bf16 v22, v103, v47, v22
    v_dot2_f32_bf16 v23, v103, v46, v23
    v_dot2_f32_bf16 v24, v104, v47, v24
    v_dot2_f32_bf16 v25, v104, v46, v25
    v_dot2_f32_bf16 v26, v105, v47, v26
    v_dot2_f32_bf16 v27, v105, v46, v27
    v_dot2_f32_bf16 v28, v106, v47, v28
    v_dot2_f32_bf16 v29, v106, v46, v29
    v_dot2_f32_bf16 v30, v107, v47, v30
    v_dot2_f32_bf16 v31, v107, v46, v31
    v_dot2_f32_bf16 v32, v108, v47, v32
    v_dot2_f32_bf16 v33, v108, v46, v33
    v_dot2_f32_bf16 v34, v109, v47, v34
    v_dot2_f32_bf16 v35, v109, v46, v35
    v_dot2_f32_bf16 v36, v110, v47, v36
    v_dot2_f32_bf16 v37, v110, v46, v37
    v_dot2_f32_bf16 v38, v111, v47, v38
    v_dot2_f32_bf16 v39, v111, v46, v39
    s_branch L_sdone_55
L_sdone_55:
L_tail_start:
    s_nop 2
    v_mov_b32 v44, v40
    s_nop 1
    v_max_f32_dpp v44, v44, v44 row_ror:8 row_mask:0xf bank_mask:0xf
    v_mov_b32 v45, v44
    s_nop 1
    v_permlane16_swap_b32 v45, v44
    s_nop 0
    v_max_f32 v44, v44, v45
    v_mov_b32 v45, v44
    s_nop 1
    v_permlane32_swap_b32 v45, v44
    s_nop 0
    v_max_f32 v44, v44, v45
    v_sub_f32 v46, v40, v44
    v_mul_f32 v46, s31, v46
    v_exp_f32 v46, v46
    s_nop 0
    v_mul_f32 v41, v41, v46
    v_pk_mul_f32 v[16:17], v[16:17], v[46:47] op_sel_hi:[1,0]
    v_pk_mul_f32 v[18:19], v[18:19], v[46:47] op_sel_hi:[1,0]
    v_pk_mul_f32 v[20:21], v[20:21], v[46:47] op_sel_hi:[1,0]
    v_pk_mul_f32 v[22:23], v[22:23], v[46:47] op_sel_hi:[1,0]
    v_pk_mul_f32 v[24:25], v[24:25], v[46:47] op_sel_hi:[1,0]
    v_pk_mul_f32 v[26:27], v[26:27], v[46:47] op_sel_hi:[1,0]
    v_pk_mul_f32 v[28:29], v[28:29], v[46:47] op_sel_hi:[1,0]
    v_pk_mul_f32 v[30:31], v[30:31], v[46:47] op_sel_hi:[1,0]
    v_pk_mul_f32 v[32:33], v[32:33], v[46:47] op_sel_hi:[1,0]
    v_pk_mul_f32 v[34:35], v[34:35], v[46:47] op_sel_hi:[1,0]
    v_pk_mul_f32 v[36:37], v[36:37], v[46:47] op_sel_hi:[1,0]
    v_pk_mul_f32 v[38:39], v[38:39], v[46:47] op_sel_hi:[1,0]
    s_nop 1
    v_add_f32_dpp v41, v41, v41 row_ror:8 row_mask:0xf bank_mask:0xf
    v_mov_b32 v45, v41
    s_nop 1
    v_permlane16_swap_b32 v45, v41
    s_nop 0
    v_add_f32 v41, v41, v45
    v_mov_b32 v45, v41
    s_nop 1
    v_permlane32_swap_b32 v45, v41
    s_nop 0
    v_add_f32 v41, v41, v45
    v_mov_b32 v45, v41
    s_lshl_b32 s33, s3, 3
    v_mov_b32 v48, s33
    ds_write_b64 v48, v[44:45] offset:34816
    s_nop 2
    v_add_f32_dpp v16, v16, v16 row_ror:8 row_mask:0xf bank_mask:0xf
    v_add_f32_dpp v17, v17, v17 row_ror:8 row_mask:0xf bank_mask:0xf
    v_add_f32_dpp v18, v18, v18 row_ror:8 row_mask:0xf bank_mask:0xf
    v_add_f32_dpp v19, v19, v19 row_ror:8 row_mask:0xf bank_mask:0xf
    v_add_f32_dpp v20, v20, v20 row_ror:8 row_mask:0xf bank_mask:0xf
    v_add_f32_dpp v21, v21, v21 row_ror:8 row_mask:0xf bank_mask:0xf
    v_add_f32_dpp v22, v22, v22 row_ror:8 row_mask:0xf bank_mask:0xf
    v_add_f32_dpp v23, v23, v23 row_ror:8 row_mask:0xf bank_mask:0xf
    v_add_f32_dpp v24, v24, v24 row_ror:8 row_mask:0xf bank_mask:0xf
    v_add_f32_dpp v25, v25, v25 row_ror:8 row_mask:0xf bank_mask:0xf
    v_add_f32_dpp v26, v26, v26 row_ror:8 row_mask:0xf bank_mask:0xf
    v_add_f32_dpp v27, v27, v27 row_ror:8 row_mask:0xf bank_mask:0xf
    v_add_f32_dpp v28, v28, v28 row_ror:8 row_mask:0xf bank_mask:0xf
    v_add_f32_dpp v29, v29, v29 row_ror:8 row_mask:0xf bank_mask:0xf
    v_add_f32_dpp v30, v30, v30 row_ror:8 row_mask:0xf bank_mask:0xf
    v_add_f32_dpp v31, v31, v31 row_ror:8 row_mask:0xf bank_mask:0xf
    v_add_f32_dpp v32, v32, v32 row_ror:8 row_mask:0xf bank_mask:0xf
    v_add_f32_dpp v33, v33, v33 row_ror:8 row_mask:0xf bank_mask:0xf
    v_add_f32_dpp v34, v34, v34 row_ror:8 row_mask:0xf bank_mask:0xf
    v_add_f32_dpp v35, v35, v35 row_ror:8 row_mask:0xf bank_mask:0xf
    v_add_f32_dpp v36, v36, v36 row_ror:8 row_mask:0xf bank_mask:0xf
    v_add_f32_dpp v37, v37, v37 row_ror:8 row_mask:0xf bank_mask:0xf
    v_add_f32_dpp v38, v38, v38 row_ror:8 row_mask:0xf bank_mask:0xf
    v_add_f32_dpp v39, v39, v39 row_ror:8 row_mask:0xf bank_mask:0xf
    s_nop 1
    v_permlane16_swap_b32 v16, v28
    v_permlane16_swap_b32 v17, v29
    v_permlane16_swap_b32 v18, v30
    v_permlane16_swap_b32 v19, v31
    v_permlane16_swap_b32 v20, v32
    v_permlane16_swap_b32 v21, v33
    v_permlane16_swap_b32 v22, v34
    v_permlane16_swap_b32 v23, v35
    v_permlane16_swap_b32 v24, v36
    v_permlane16_swap_b32 v25, v37
    v_permlane16_swap_b32 v26, v38
    v_permlane16_swap_b32 v27, v39
    s_nop 0
    v_pk_add_f32 v[16:17], v[16:17], v[28:29]
    v_pk_add_f32 v[18:19], v[18:19], v[30:31]
    v_pk_add_f32 v[20:21], v[20:21], v[32:33]
    v_pk_add_f32 v[22:23], v[22:23], v[34:35]
    v_pk_add_f32 v[24:25], v[24:25], v[36:37]
    v_pk_add_f32 v[26:27], v[26:27], v[38:39]
    s_nop 1
    v_permlane32_swap_b32 v16, v22
    v_permlane32_swap_b32 v17, v23
    v_permlane32_swap_b32 v18, v24
    v_permlane32_swap_b32 v19, v25
    v_permlane32_swap_b32 v20, v26
    v_permlane32_swap_b32 v21, v27
    s_nop 0
    v_pk_add_f32 v[16:17], v[16:17], v[22:23]
    v_pk_add_f32 v[18:19], v[18:19], v[24:25]
    v_pk_add_f32 v[20:21], v[20:21], v[26:27]
    ds_write_b64 v190, v[16:17] offset:0
    ds_write_b64 v190, v[18:19] offset:8
    ds_write_b64 v190, v[20:21] offset:16
    s_waitcnt lgkmcnt(0)
    s_barrier
    ds_read_b128 v[100:103], v3 offset:34816
    ds_read_b128 v[104:107], v3 offset:34832
    ds_read_b32 v96, v191 offset:0
    ds_read_b32 v97, v191 offset:768
    ds_read_b32 v98, v191 offset:1536
    ds_read_b32 v99, v191 offset:2304
    s_waitcnt lgkmcnt(4)
    v_max_f32 v108, v100, v102
    v_max3_f32 v108, v108, v104, v106
    v_mul_f32 v114, s31, v108
    v_fma_f32 v110, v100, s31, -v114
    v_fma_f32 v111, v102, s31, -v114
    v_fma_f32 v112, v104, s31, -v114
    v_fma_f32 v113, v106, s31, -v114
    v_exp_f32 v110, v110
    v_exp_f32 v111, v111
    v_exp_f32 v112, v112
    v_exp_f32 v113, v113
    s_cmp_ge_u32 s3, 3
    s_cbranch_scc1 L_t1w3_84
    s_waitcnt lgkmcnt(0)
    v_mul_f32 v96, v96, v110
    v_fmac_f32 v96, v97, v111
    v_fmac_f32 v96, v98, v112
    v_fmac_f32 v96, v99, v113
    buffer_store_dword v96, v191, s[16:19], s5 offen sc1
    s_branch L_t1j_85
L_t1w3_84:
    v_mul_f32 v109, v101, v110
    v_fmac_f32 v109, v103, v111
    v_fmac_f32 v109, v105, v112
    v_fmac_f32 v109, v107, v113
    v_mov_b32 v110, 0
    v_mov_b32 v111, 0
    s_mov_b64 exec, 1
    buffer_store_dwordx4 v[108:111], v3, s[16:19], s5 offen offset:768 sc1
    s_mov_b64 exec, -1
    s_waitcnt lgkmcnt(0)
L_t1j_85:
    s_cmp_ge_u32 s2, 160
    s_cbranch_scc1 L_rolem_86
    v_lshrrev_b32 v45, 5, v1
    v_mul_u32_u24 v45, 24, v45
    v_bfe_u32 v46, v1, 2, 3
    v_add_lshl_u32 v45, v45, v46, 2
    s_mul_i32 s4, s3, 768
    v_add_u32 v170, s4, v45
    v_and_b32 v45, 3, v1
    v_lshlrev_b32 v45, 5, v45
    v_bfe_u32 v46, v1, 4, 1
    v_lshl_add_u32 v45, v46, 4, v45
    v_lshrrev_b32 v46, 5, v1
    v_lshl_add_u32 v45, v46, 3, v45
    s_lshl_b32 s4, s3, 7
    v_add_u32 v171, s4, v45
    v_and_b32 v45, 31, v0
    v_lshlrev_b32 v172, 2, v45
    s_and_b32 s6, s2, 7
    s_mul_i32 s6, s6, 2560
    s_lshr_b32 s4, s2, 3
    s_lshl_b32 s4, s4, 7
    s_add_u32 s6, s6, s4
    s_add_u32 s6, s6, 1572864
    s_mov_b32 s7, 0x07060302
    s_and_b32 s32, s2, 7
    s_lshl_b32 s32, s32, 2
    s_add_u32 s32, s32, s3
    s_lshl_b32 s32, s32, 13
    s_add_u32 s32, s32, 327680
    s_add_u32 s33, s32, 4096
    v_lshlrev_b32 v42, 4, v1
    s_mul_i32 s34, s3, 768
    v_add_u32 v44, s34, v42
    s_bfm_b64 exec, 49, 0
    s_mov_b32 s66, 0
L_wspin_88:
    buffer_load_dwordx4 v[64:67], v42, s[16:19], s32 offen offset:0 sc1
    buffer_load_dwordx4 v[68:71], v42, s[16:19], s32 offen offset:1024 sc1
    buffer_load_dwordx4 v[72:75], v42, s[16:19], s32 offen offset:2048 sc1
    buffer_load_dwordx4 v[76:79], v42, s[16:19], s32 offen offset:3072 sc1
    buffer_load_dwordx4 v[80:83], v42, s[16:19], s33 offen offset:0 sc1
    buffer_load_dwordx4 v[84:87], v42, s[16:19], s33 offen offset:1024 sc1
    buffer_load_dwordx4 v[88:91], v42, s[16:19], s33 offen offset:2048 sc1
    buffer_load_dwordx4 v[92:95], v42, s[16:19], s33 offen offset:3072 sc1
    s_waitcnt vmcnt(0)
    v_max3_u32 v43, v64, v65, v66
    v_max3_u32 v43, v43, v67, v68
    v_max3_u32 v43, v43, v69, v70
    v_max3_u32 v43, v43, v71, v72
    v_max3_u32 v43, v43, v73, v74
    v_max3_u32 v43, v43, v75, v76
    v_max3_u32 v43, v43, v77, v78
    v_max3_u32 v43, v43, v79, v80
    v_max3_u32 v43, v43, v81, v82
    v_max3_u32 v43, v43, v83, v84
    v_max3_u32 v43, v43, v85, v86
    v_max3_u32 v43, v43, v87, v88
    v_max3_u32 v43, v43, v89, v90
    v_max3_u32 v43, v43, v91, v92
    v_max3_u32 v43, v43, v93, v94
    v_max_u32 v43, v43, v95
    v_cmp_eq_u32 vcc, -1, v43
    s_cbranch_vccz L_ok_89
    s_add_u32 s66, s66, 1
    s_cmp_lt_u32 s66, 200000
    s_cbranch_scc1 L_wspin_88
L_ok_89:
    v_max3_f32 v96, v64, v68, v72
    v_max3_f32 v96, v96, v76, v80
    v_max3_f32 v96, v96, v84, v88
    v_max_f32 v96, v96, v92
    v_mul_f32 v96, s31, v96
    v_fma_f32 v98, v64, s31, -v96
    v_fma_f32 v99, v68, s31, -v96
    v_fma_f32 v100, v72, s31, -v96
    v_fma_f32 v101, v76, s31, -v96
    v_fma_f32 v102, v80, s31, -v96
    v_fma_f32 v103, v84, s31, -v96
    v_fma_f32 v104, v88, s31, -v96
    v_fma_f32 v105, v92, s31, -v96
    v_exp_f32 v98, v98
    v_exp_f32 v99, v99
    v_exp_f32 v100, v100
    v_exp_f32 v101, v101
    v_exp_f32 v102, v102
    v_exp_f32 v103, v103
    v_exp_f32 v104, v104
    v_exp_f32 v105, v105
    v_mul_f32 v97, v65, v98
    v_fmac_f32 v97, v69, v99
    v_fmac_f32 v97, v73, v100
    v_fmac_f32 v97, v77, v101
    v_fmac_f32 v97, v81, v102
    v_fmac_f32 v97, v85, v103
    v_fmac_f32 v97, v89, v104
    v_fmac_f32 v97, v93, v105
    v_rcp_f32 v97, v97
    s_nop 0
    v_mul_f32 v98, v98, v97
    v_mul_f32 v99, v99, v97
    v_mul_f32 v100, v100, v97
    v_mul_f32 v101, v101, v97
    v_mul_f32 v102, v102, v97
    v_mul_f32 v103, v103, v97
    v_mul_f32 v104, v104, v97
    v_mul_f32 v105, v105, v97
    v_readlane_b32 s68, v98, 48
    v_readlane_b32 s69, v99, 48
    v_readlane_b32 s70, v100, 48
    v_readlane_b32 s71, v101, 48
    v_readlane_b32 s72, v102, 48
    v_readlane_b32 s73, v103, 48
    v_readlane_b32 s74, v104, 48
    v_readlane_b32 s75, v105, 48
    s_nop 1
    v_mul_f32 v108, s68, v64
    v_mul_f32 v109, s68, v65
    v_mul_f32 v110, s68, v66
    v_mul_f32 v111, s68, v67
    v_fmac_f32 v108, s69, v68
    v_fmac_f32 v109, s69, v69
    v_fmac_f32 v110, s69, v70
    v_fmac_f32 v111, s69, v71
    v_fmac_f32 v108, s70, v72
    v_fmac_f32 v109, s70, v73
    v_fmac_f32 v110, s70, v74
    v_fmac_f32 v111, s70, v75
    v_fmac_f32 v108, s71, v76
    v_fmac_f32 v109, s71, v77
    v_fmac_f32 v110, s71, v78
    v_fmac_f32 v111, s71, v79
    v_fmac_f32 v108, s72, v80
    v_fmac_f32 v109, s72, v81
    v_fmac_f32 v110, s72, v82
    v_fmac_f32 v111, s72, v83
    v_fmac_f32 v108, s73, v84
    v_fmac_f32 v109, s73, v85
    v_fmac_f32 v110, s73, v86
    v_fmac_f32 v111, s73, v87
    v_fmac_f32 v108, s74, v88
    v_fmac_f32 v109, s74, v89
    v_fmac_f32 v110, s74, v90
    v_fmac_f32 v111, s74, v91
    v_fmac_f32 v108, s75, v92
    v_fmac_f32 v109, s75, v93
    v_fmac_f32 v110, s75, v94
    v_fmac_f32 v111, s75, v95
    v_cvt_pk_bf16_f32 v108, v108, v108
    v_and_b32 v108, 0xffff0000, v108
    v_cvt_pk_bf16_f32 v109, v109, v109
    v_and_b32 v109, 0xffff0000, v109
    v_cvt_pk_bf16_f32 v110, v110, v110
    v_and_b32 v110, 0xffff0000, v110
    v_cvt_pk_bf16_f32 v111, v111, v111
    v_and_b32 v111, 0xffff0000, v111
    s_bfm_b64 exec, 48, 0
    ds_write_b128 v44, v[108:111] offset:35840
    s_mov_b64 exec, -1
    s_waitcnt lgkmcnt(0)
    ds_read_b32 v112, v170 offset:35840
    ds_read_b32 v113, v170 offset:36032
    ds_read_b32 v114, v170 offset:36224
    ds_read_b32 v115, v170 offset:36416
    ds_read_b32 v116, v170 offset:35872
    ds_read_b32 v117, v170 offset:36064
    ds_read_b32 v118, v170 offset:36256
    ds_read_b32 v119, v170 offset:36448
    ds_read_b32 v120, v170 offset:35904
    ds_read_b32 v121, v170 offset:36096
    ds_read_b32 v122, v170 offset:36288
    ds_read_b32 v123, v170 offset:36480
    s_waitcnt lgkmcnt(10)
    v_perm_b32 v124, v113, v112, s7
    v_dot2_f32_bf16 v160, v192, v124, 0
    v_dot2_f32_bf16 v161, v196, v124, 0
    v_dot2_f32_bf16 v162, v193, v124, 0
    v_dot2_f32_bf16 v163, v197, v124, 0
    v_dot2_f32_bf16 v164, v194, v124, 0
    v_dot2_f32_bf16 v165, v198, v124, 0
    v_dot2_f32_bf16 v166, v195, v124, 0
    v_dot2_f32_bf16 v167, v199, v124, 0
    s_waitcnt lgkmcnt(8)
    v_perm_b32 v125, v115, v114, s7
    v_dot2_f32_bf16 v160, v200, v125, v160
    v_dot2_f32_bf16 v161, v204, v125, v161
    v_dot2_f32_bf16 v162, v201, v125, v162
    v_dot2_f32_bf16 v163, v205, v125, v163
    v_dot2_f32_bf16 v164, v202, v125, v164
    v_dot2_f32_bf16 v165, v206, v125, v165
    v_dot2_f32_bf16 v166, v203, v125, v166
    v_dot2_f32_bf16 v167, v207, v125, v167
    s_waitcnt lgkmcnt(6)
    v_perm_b32 v124, v117, v116, s7
    v_dot2_f32_bf16 v160, v208, v124, v160
    v_dot2_f32_bf16 v161, v212, v124, v161
    v_dot2_f32_bf16 v162, v209, v124, v162
    v_dot2_f32_bf16 v163, v213, v124, v163
    v_dot2_f32_bf16 v164, v210, v124, v164
    v_dot2_f32_bf16 v165, v214, v124, v165
    v_dot2_f32_bf16 v166, v211, v124, v166
    v_dot2_f32_bf16 v167, v215, v124, v167
    s_waitcnt lgkmcnt(4)
    v_perm_b32 v125, v119, v118, s7
    v_dot2_f32_bf16 v160, v216, v125, v160
    v_dot2_f32_bf16 v161, v220, v125, v161
    v_dot2_f32_bf16 v162, v217, v125, v162
    v_dot2_f32_bf16 v163, v221, v125, v163
    v_dot2_f32_bf16 v164, v218, v125, v164
    v_dot2_f32_bf16 v165, v222, v125, v165
    v_dot2_f32_bf16 v166, v219, v125, v166
    v_dot2_f32_bf16 v167, v223, v125, v167
    s_waitcnt lgkmcnt(2)
    v_perm_b32 v124, v121, v120, s7
    v_dot2_f32_bf16 v160, v224, v124, v160
    v_dot2_f32_bf16 v161, v228, v124, v161
    v_dot2_f32_bf16 v162, v225, v124, v162
    v_dot2_f32_bf16 v163, v229, v124, v163
    v_dot2_f32_bf16 v164, v226, v124, v164
    v_dot2_f32_bf16 v165, v230, v124, v165
    v_dot2_f32_bf16 v166, v227, v124, v166
    v_dot2_f32_bf16 v167, v231, v124, v167
    s_waitcnt lgkmcnt(0)
    v_perm_b32 v125, v123, v122, s7
    v_dot2_f32_bf16 v160, v232, v125, v160
    v_dot2_f32_bf16 v161, v236, v125, v161
    v_dot2_f32_bf16 v162, v233, v125, v162
    v_dot2_f32_bf16 v163, v237, v125, v163
    v_dot2_f32_bf16 v164, v234, v125, v164
    v_dot2_f32_bf16 v165, v238, v125, v165
    v_dot2_f32_bf16 v166, v235, v125, v166
    v_dot2_f32_bf16 v167, v239, v125, v167
    s_nop 2
    v_add_f32_dpp v160, v160, v160 row_ror:4 row_mask:0xf bank_mask:0xf
    v_add_f32_dpp v161, v161, v161 row_ror:4 row_mask:0xf bank_mask:0xf
    v_add_f32_dpp v162, v162, v162 row_ror:4 row_mask:0xf bank_mask:0xf
    v_add_f32_dpp v163, v163, v163 row_ror:4 row_mask:0xf bank_mask:0xf
    v_add_f32_dpp v164, v164, v164 row_ror:4 row_mask:0xf bank_mask:0xf
    v_add_f32_dpp v165, v165, v165 row_ror:4 row_mask:0xf bank_mask:0xf
    v_add_f32_dpp v166, v166, v166 row_ror:4 row_mask:0xf bank_mask:0xf
    v_add_f32_dpp v167, v167, v167 row_ror:4 row_mask:0xf bank_mask:0xf
    v_add_f32_dpp v160, v160, v160 row_ror:8 row_mask:0xf bank_mask:0xf
    v_add_f32_dpp v161, v161, v161 row_ror:8 row_mask:0xf bank_mask:0xf
    v_add_f32_dpp v162, v162, v162 row_ror:8 row_mask:0xf bank_mask:0xf
    v_add_f32_dpp v163, v163, v163 row_ror:8 row_mask:0xf bank_mask:0xf
    v_add_f32_dpp v164, v164, v164 row_ror:8 row_mask:0xf bank_mask:0xf
    v_add_f32_dpp v165, v165, v165 row_ror:8 row_mask:0xf bank_mask:0xf
    v_add_f32_dpp v166, v166, v166 row_ror:8 row_mask:0xf bank_mask:0xf
    v_add_f32_dpp v167, v167, v167 row_ror:8 row_mask:0xf bank_mask:0xf
    s_nop 1
    v_permlane16_swap_b32 v160, v164
    v_permlane16_swap_b32 v161, v165
    v_permlane16_swap_b32 v162, v166
    v_permlane16_swap_b32 v163, v167
    s_nop 0
    v_pk_add_f32 v[160:161], v[160:161], v[164:165]
    v_pk_add_f32 v[162:163], v[162:163], v[166:167]
    s_nop 1
    v_permlane32_swap_b32 v160, v162
    v_permlane32_swap_b32 v161, v163
    s_nop 0
    v_pk_add_f32 v[160:161], v[160:161], v[162:163]
    ds_write_b64 v171, v[160:161] offset:3072
    s_waitcnt lgkmcnt(0)
    s_barrier
    s_cmp_ge_u32 s3, 1
    s_cbranch_scc1 L_wd_90
    ds_read_b32 v112, v172 offset:3072
    ds_read_b32 v113, v172 offset:3200
    ds_read_b32 v114, v172 offset:3328
    ds_read_b32 v115, v172 offset:3456
    s_bfm_b64 exec, 32, 0
    s_waitcnt lgkmcnt(0)
    v_add_f32 v112, v112, v113
    v_add_f32 v114, v114, v115
    v_add_f32 v112, v112, v114
    buffer_store_dword v112, v172, s[16:19], s6 offen sc1
    s_mov_b64 exec, -1
L_wd_90:
    s_branch L_fin_87
L_rolem_86:
    v_and_b32 v42, 127, v0
    v_lshrrev_b32 v42, 1, v42
    v_lshlrev_b32 v42, 1, v42
    s_mul_i32 s32, s3, 1280
    v_add_u32 v110, s32, v42
    v_and_b32 v42, 1, v1
    v_lshlrev_b32 v42, 5, v42
    v_bfe_u32 v43, v1, 4, 1
    v_lshl_add_u32 v42, v43, 4, v42
    v_lshrrev_b32 v43, 5, v1
    v_lshl_add_u32 v42, v43, 3, v42
    s_lshl_b32 s32, s3, 6
    v_add_u32 v111, s32, v42
    v_and_b32 v42, 15, v1
    v_lshlrev_b32 v112, 2, v42
    s_lshl_b32 s32, s3, 7
    v_lshlrev_b32 v42, 2, v1
    v_add_u32 v113, s32, v42
    v_mul_u32_u24 v42, 205, v0
    v_lshrrev_b32 v42, 14, v42
    v_lshl_add_u32 v114, v42, 2, s32
    v_mul_u32_u24 v43, 80, v42
    v_sub_u32 v43, v0, v43
    v_lshlrev_b32 v43, 5, v43
    v_mul_u32_u24 v42, 2560, v42
    v_add_u32 v115, v43, v42
    v_lshlrev_b32 v116, 4, v0
    v_lshrrev_b32 v42, 2, v0
    v_mul_u32_u24 v42, 6144, v42
    v_and_b32 v43, 3, v0
    v_lshl_add_u32 v117, v43, 4, v42
    s_lshl_b32 s74, s67, 6
    s_add_u32 s74, s74, 655360
    s_mov_b32 s4, 0xbfb8aa3b
    s_mov_b32 s75, 0x07060302
    s_movk_i32 s5, 240
    s_movk_i32 s6, 160
    v_cmp_gt_u32 s[68:69], 16, v1
    v_cmp_gt_u32 s[70:71], s5, v0
    v_cmp_gt_u32 s[72:73], s6, v0
    s_mul_i32 s32, s3, 640
    s_add_u32 s32, s32, 1572864
    s_add_u32 s33, s32, 5120
    s_add_u32 s34, s32, 10240
    s_add_u32 s35, s32, 15360
    v_lshlrev_b32 v42, 4, v1
    v_lshlrev_b32 v100, 16, v176
    v_and_b32 v101, 0xffff0000, v176
    v_lshlrev_b32 v102, 16, v177
    v_and_b32 v103, 0xffff0000, v177
    s_mul_i32 s66, s3, 320
    v_lshlrev_b32 v44, 3, v1
    v_add_u32 v44, s66, v44
    s_bfm_b64 exec, 40, 0
    s_mov_b32 s66, 0
L_hspin_91:
    buffer_load_dwordx4 v[64:67], v42, s[16:19], s32 offen offset:0 sc1
    buffer_load_dwordx4 v[68:71], v42, s[16:19], s32 offen offset:2560 sc1
    buffer_load_dwordx4 v[72:75], v42, s[16:19], s33 offen offset:0 sc1
    buffer_load_dwordx4 v[76:79], v42, s[16:19], s33 offen offset:2560 sc1
    buffer_load_dwordx4 v[80:83], v42, s[16:19], s34 offen offset:0 sc1
    buffer_load_dwordx4 v[84:87], v42, s[16:19], s34 offen offset:2560 sc1
    buffer_load_dwordx4 v[88:91], v42, s[16:19], s35 offen offset:0 sc1
    buffer_load_dwordx4 v[92:95], v42, s[16:19], s35 offen offset:2560 sc1
    s_waitcnt vmcnt(0)
    v_max3_u32 v43, v64, v65, v66
    v_max3_u32 v43, v43, v67, v68
    v_max3_u32 v43, v43, v69, v70
    v_max3_u32 v43, v43, v71, v72
    v_max3_u32 v43, v43, v73, v74
    v_max3_u32 v43, v43, v75, v76
    v_max3_u32 v43, v43, v77, v78
    v_max3_u32 v43, v43, v79, v80
    v_max3_u32 v43, v43, v81, v82
    v_max3_u32 v43, v43, v83, v84
    v_max3_u32 v43, v43, v85, v86
    v_max3_u32 v43, v43, v87, v88
    v_max3_u32 v43, v43, v89, v90
    v_max3_u32 v43, v43, v91, v92
    v_max3_u32 v43, v43, v93, v94
    v_max_u32 v43, v43, v95
    v_cmp_eq_u32 vcc, -1, v43
    s_cbranch_vccz L_ok_92
    s_add_u32 s66, s66, 1
    s_cmp_lt_u32 s66, 200000
    s_cbranch_scc1 L_hspin_91
L_ok_92:
    v_pk_add_f32 v[64:65], v[64:65], v[68:69]
    v_pk_add_f32 v[72:73], v[72:73], v[76:77]
    v_pk_add_f32 v[80:81], v[80:81], v[84:85]
    v_pk_add_f32 v[88:89], v[88:89], v[92:93]
    v_pk_add_f32 v[66:67], v[66:67], v[70:71]
    v_pk_add_f32 v[74:75], v[74:75], v[78:79]
    v_pk_add_f32 v[82:83], v[82:83], v[86:87]
    v_pk_add_f32 v[90:91], v[90:91], v[94:95]
    v_pk_add_f32 v[64:65], v[64:65], v[72:73]
    v_pk_add_f32 v[80:81], v[80:81], v[88:89]
    v_pk_add_f32 v[66:67], v[66:67], v[74:75]
    v_pk_add_f32 v[82:83], v[82:83], v[90:91]
    v_pk_add_f32 v[64:65], v[64:65], v[80:81]
    v_pk_add_f32 v[66:67], v[66:67], v[82:83]
    v_cvt_pk_bf16_f32 v68, v64, v65
    v_cvt_pk_bf16_f32 v69, v66, v67
    v_lshlrev_b32 v64, 16, v68
    v_and_b32 v65, 0xffff0000, v68
    v_lshlrev_b32 v66, 16, v69
    v_and_b32 v67, 0xffff0000, v69
    v_pk_add_f32 v[64:65], v[64:65], v[100:101]
    v_pk_add_f32 v[66:67], v[66:67], v[102:103]
    v_cvt_pk_bf16_f32 v68, v64, v65
    v_cvt_pk_bf16_f32 v69, v66, v67
    ds_write_b64 v44, v[68:69] offset:29696
    s_mov_b64 exec, -1
    v_lshlrev_b32 v42, 2, v1
    s_waitcnt lgkmcnt(0)
    s_barrier
    ds_read_b32 v64, v42 offset:29696
    ds_read_b32 v65, v42 offset:29952
    ds_read_b32 v66, v42 offset:30208
    ds_read_b32 v67, v42 offset:30464
    ds_read_b32 v68, v42 offset:30720
    s_mul_i32 s32, s3, 1280
    v_add_u32 v42, s32, v42
    s_waitcnt lgkmcnt(0)
    v_lshlrev_b32 v70, 16, v64
    v_and_b32 v71, 0xffff0000, v64
    v_lshlrev_b32 v72, 16, v65
    v_and_b32 v73, 0xffff0000, v65
    v_lshlrev_b32 v74, 16, v66
    v_and_b32 v75, 0xffff0000, v66
    v_lshlrev_b32 v76, 16, v67
    v_and_b32 v77, 0xffff0000, v67
    v_lshlrev_b32 v78, 16, v68
    v_and_b32 v79, 0xffff0000, v68
    s_nop 0
    v_readfirstlane_b32 s32, v70
    s_nop 1
    v_subrev_f32 v46, s32, v70
    v_mul_f32 v47, v46, v46
    v_subrev_f32 v48, s32, v71
    v_add_f32 v46, v46, v48
    v_fmac_f32 v47, v48, v48
    v_subrev_f32 v48, s32, v72
    v_add_f32 v46, v46, v48
    v_fmac_f32 v47, v48, v48
    v_subrev_f32 v48, s32, v73
    v_add_f32 v46, v46, v48
    v_fmac_f32 v47, v48, v48
    v_subrev_f32 v48, s32, v74
    v_add_f32 v46, v46, v48
    v_fmac_f32 v47, v48, v48
    v_subrev_f32 v48, s32, v75
    v_add_f32 v46, v46, v48
    v_fmac_f32 v47, v48, v48
    v_subrev_f32 v48, s32, v76
    v_add_f32 v46, v46, v48
    v_fmac_f32 v47, v48, v48
    v_subrev_f32 v48, s32, v77
    v_add_f32 v46, v46, v48
    v_fmac_f32 v47, v48, v48
    v_subrev_f32 v48, s32, v78
    v_add_f32 v46, v46, v48
    v_fmac_f32 v47, v48, v48
    v_subrev_f32 v48, s32, v79
    v_add_f32 v46, v46, v48
    v_fmac_f32 v47, v48, v48
    s_nop 1
    v_add_f32_dpp v46, v46, v46 quad_perm:[1,0,3,2] row_mask:0xf bank_mask:0xf
    v_add_f32_dpp v47, v47, v47 quad_perm:[1,0,3,2] row_mask:0xf bank_mask:0xf
    s_nop 1
    v_add_f32_dpp v46, v46, v46 quad_perm:[2,3,0,1] row_mask:0xf bank_mask:0xf
    v_add_f32_dpp v47, v47, v47 quad_perm:[2,3,0,1] row_mask:0xf bank_mask:0xf
    s_nop 1
    v_add_f32_dpp v46, v46, v46 row_half_mirror row_mask:0xf bank_mask:0xf
    v_add_f32_dpp v47, v47, v47 row_half_mirror row_mask:0xf bank_mask:0xf
    s_nop 1
    v_add_f32_dpp v46, v46, v46 row_mirror row_mask:0xf bank_mask:0xf
    v_add_f32_dpp v47, v47, v47 row_mirror row_mask:0xf bank_mask:0xf
    v_mov_b32 v48, v46
    v_mov_b32 v49, v47
    s_nop 1
    v_permlane16_swap_b32 v48, v46
    v_permlane16_swap_b32 v49, v47
    s_nop 0
    v_add_f32 v46, v46, v48
    v_add_f32 v47, v47, v49
    v_mov_b32 v48, v46
    v_mov_b32 v49, v47
    s_nop 1
    v_permlane32_swap_b32 v48, v46
    v_permlane32_swap_b32 v49, v47
    s_nop 0
    v_add_f32 v46, v46, v48
    v_add_f32 v47, v47, v49
    v_mul_f32 v46, 0x3acccccd, v46
    v_mul_f32 v47, 0x3acccccd, v47
    v_fma_f32 v47, -v46, v46, v47
    v_max_f32 v47, 0, v47
    v_add_f32 v51, s32, v46
    v_cvt_pk_bf16_f32 v47, v47, v47
    v_and_b32 v47, 0xffff0000, v47
    v_add_f32 v47, 0x3727c5ac, v47
    v_cvt_pk_bf16_f32 v47, v47, v47
    v_and_b32 v47, 0xffff0000, v47
    v_sqrt_f32 v50, v47
    v_cvt_pk_bf16_f32 v51, v51, v51
    v_and_b32 v51, 0xffff0000, v51
    v_cvt_pk_bf16_f32 v50, v50, v50
    v_and_b32 v50, 0xffff0000, v50
    v_rcp_f32 v50, v50
    v_sub_f32 v70, v70, v51
    v_sub_f32 v71, v71, v51
    v_cvt_pk_bf16_f32 v48, v70, v71
    v_lshlrev_b32 v70, 16, v48
    v_and_b32 v71, 0xffff0000, v48
    v_mul_f32 v70, v70, v50
    v_mul_f32 v71, v71, v50
    v_sub_f32 v72, v72, v51
    v_sub_f32 v73, v73, v51
    v_cvt_pk_bf16_f32 v48, v72, v73
    v_lshlrev_b32 v72, 16, v48
    v_and_b32 v73, 0xffff0000, v48
    v_mul_f32 v72, v72, v50
    v_mul_f32 v73, v73, v50
    v_sub_f32 v74, v74, v51
    v_sub_f32 v75, v75, v51
    v_cvt_pk_bf16_f32 v48, v74, v75
    v_lshlrev_b32 v74, 16, v48
    v_and_b32 v75, 0xffff0000, v48
    v_mul_f32 v74, v74, v50
    v_mul_f32 v75, v75, v50
    v_sub_f32 v76, v76, v51
    v_sub_f32 v77, v77, v51
    v_cvt_pk_bf16_f32 v48, v76, v77
    v_lshlrev_b32 v76, 16, v48
    v_and_b32 v77, 0xffff0000, v48
    v_mul_f32 v76, v76, v50
    v_mul_f32 v77, v77, v50
    v_sub_f32 v78, v78, v51
    v_sub_f32 v79, v79, v51
    v_cvt_pk_bf16_f32 v48, v78, v79
    v_lshlrev_b32 v78, 16, v48
    v_and_b32 v79, 0xffff0000, v48
    v_mul_f32 v78, v78, v50
    v_mul_f32 v79, v79, v50
    v_cvt_pk_bf16_f32 v64, v70, v71
    ds_write_b32 v42, v64 offset:24576
    v_cvt_pk_bf16_f32 v65, v72, v73
    ds_write_b32 v42, v65 offset:24832
    v_cvt_pk_bf16_f32 v66, v74, v75
    ds_write_b32 v42, v66 offset:25088
    v_cvt_pk_bf16_f32 v67, v76, v77
    ds_write_b32 v42, v67 offset:25344
    v_cvt_pk_bf16_f32 v68, v78, v79
    ds_write_b32 v42, v68 offset:25600
    s_waitcnt vmcnt(0) lgkmcnt(0)
    ds_read_u16 v80, v110 offset:24576
    ds_read_u16 v81, v110 offset:24704
    ds_read_u16 v82, v110 offset:24832
    ds_read_u16 v83, v110 offset:24960
    ds_read_u16 v84, v110 offset:25088
    ds_read_u16 v85, v110 offset:25216
    ds_read_u16 v86, v110 offset:25344
    ds_read_u16 v87, v110 offset:25472
    ds_read_u16 v88, v110 offset:25600
    ds_read_u16 v89, v110 offset:25728
    s_waitcnt lgkmcnt(8)
    v_lshl_or_b32 v90, v81, 16, v80
    v_dot2_f32_bf16 v96, v192, v90, 0
    v_dot2_f32_bf16 v97, v196, v90, 0
    v_dot2_f32_bf16 v98, v193, v90, 0
    v_dot2_f32_bf16 v99, v197, v90, 0
    v_dot2_f32_bf16 v100, v194, v90, 0
    v_dot2_f32_bf16 v101, v198, v90, 0
    v_dot2_f32_bf16 v102, v195, v90, 0
    v_dot2_f32_bf16 v103, v199, v90, 0
    s_waitcnt lgkmcnt(6)
    v_lshl_or_b32 v91, v83, 16, v82
    v_dot2_f32_bf16 v96, v200, v91, v96
    v_dot2_f32_bf16 v97, v204, v91, v97
    v_dot2_f32_bf16 v98, v201, v91, v98
    v_dot2_f32_bf16 v99, v205, v91, v99
    v_dot2_f32_bf16 v100, v202, v91, v100
    v_dot2_f32_bf16 v101, v206, v91, v101
    v_dot2_f32_bf16 v102, v203, v91, v102
    v_dot2_f32_bf16 v103, v207, v91, v103
    s_waitcnt lgkmcnt(4)
    v_lshl_or_b32 v90, v85, 16, v84
    v_dot2_f32_bf16 v96, v208, v90, v96
    v_dot2_f32_bf16 v97, v212, v90, v97
    v_dot2_f32_bf16 v98, v209, v90, v98
    v_dot2_f32_bf16 v99, v213, v90, v99
    v_dot2_f32_bf16 v100, v210, v90, v100
    v_dot2_f32_bf16 v101, v214, v90, v101
    v_dot2_f32_bf16 v102, v211, v90, v102
    v_dot2_f32_bf16 v103, v215, v90, v103
    s_waitcnt lgkmcnt(2)
    v_lshl_or_b32 v91, v87, 16, v86
    v_dot2_f32_bf16 v96, v216, v91, v96
    v_dot2_f32_bf16 v97, v220, v91, v97
    v_dot2_f32_bf16 v98, v217, v91, v98
    v_dot2_f32_bf16 v99, v221, v91, v99
    v_dot2_f32_bf16 v100, v218, v91, v100
    v_dot2_f32_bf16 v101, v222, v91, v101
    v_dot2_f32_bf16 v102, v219, v91, v102
    v_dot2_f32_bf16 v103, v223, v91, v103
    s_waitcnt lgkmcnt(0)
    v_lshl_or_b32 v90, v89, 16, v88
    v_dot2_f32_bf16 v96, v224, v90, v96
    v_dot2_f32_bf16 v97, v228, v90, v97
    v_dot2_f32_bf16 v98, v225, v90, v98
    v_dot2_f32_bf16 v99, v229, v90, v99
    v_dot2_f32_bf16 v100, v226, v90, v100
    v_dot2_f32_bf16 v101, v230, v90, v101
    v_dot2_f32_bf16 v102, v227, v90, v102
    v_dot2_f32_bf16 v103, v231, v90, v103
    s_nop 2
    v_add_f32_dpp v96, v96, v96 quad_perm:[2,3,0,1] row_mask:0xf bank_mask:0xf
    v_add_f32_dpp v97, v97, v97 quad_perm:[2,3,0,1] row_mask:0xf bank_mask:0xf
    v_add_f32_dpp v98, v98, v98 quad_perm:[2,3,0,1] row_mask:0xf bank_mask:0xf
    v_add_f32_dpp v99, v99, v99 quad_perm:[2,3,0,1] row_mask:0xf bank_mask:0xf
    v_add_f32_dpp v100, v100, v100 quad_perm:[2,3,0,1] row_mask:0xf bank_mask:0xf
    v_add_f32_dpp v101, v101, v101 quad_perm:[2,3,0,1] row_mask:0xf bank_mask:0xf
    v_add_f32_dpp v102, v102, v102 quad_perm:[2,3,0,1] row_mask:0xf bank_mask:0xf
    v_add_f32_dpp v103, v103, v103 quad_perm:[2,3,0,1] row_mask:0xf bank_mask:0xf
    v_add_f32_dpp v96, v96, v96 row_ror:4 row_mask:0xf bank_mask:0xf
    v_add_f32_dpp v97, v97, v97 row_ror:4 row_mask:0xf bank_mask:0xf
    v_add_f32_dpp v98, v98, v98 row_ror:4 row_mask:0xf bank_mask:0xf
    v_add_f32_dpp v99, v99, v99 row_ror:4 row_mask:0xf bank_mask:0xf
    v_add_f32_dpp v100, v100, v100 row_ror:4 row_mask:0xf bank_mask:0xf
    v_add_f32_dpp v101, v101, v101 row_ror:4 row_mask:0xf bank_mask:0xf
    v_add_f32_dpp v102, v102, v102 row_ror:4 row_mask:0xf bank_mask:0xf
    v_add_f32_dpp v103, v103, v103 row_ror:4 row_mask:0xf bank_mask:0xf
    v_add_f32_dpp v96, v96, v96 row_ror:8 row_mask:0xf bank_mask:0xf
    v_add_f32_dpp v97, v97, v97 row_ror:8 row_mask:0xf bank_mask:0xf
    v_add_f32_dpp v98, v98, v98 row_ror:8 row_mask:0xf bank_mask:0xf
    v_add_f32_dpp v99, v99, v99 row_ror:8 row_mask:0xf bank_mask:0xf
    v_add_f32_dpp v100, v100, v100 row_ror:8 row_mask:0xf bank_mask:0xf
    v_add_f32_dpp v101, v101, v101 row_ror:8 row_mask:0xf bank_mask:0xf
    v_add_f32_dpp v102, v102, v102 row_ror:8 row_mask:0xf bank_mask:0xf
    v_add_f32_dpp v103, v103, v103 row_ror:8 row_mask:0xf bank_mask:0xf
    s_nop 1
    v_permlane16_swap_b32 v96, v100
    v_permlane16_swap_b32 v97, v101
    v_permlane16_swap_b32 v98, v102
    v_permlane16_swap_b32 v99, v103
    s_nop 0
    v_pk_add_f32 v[96:97], v[96:97], v[100:101]
    v_pk_add_f32 v[98:99], v[98:99], v[102:103]
    s_nop 1
    v_permlane32_swap_b32 v96, v98
    v_permlane32_swap_b32 v97, v99
    s_nop 0
    v_pk_add_f32 v[96:97], v[96:97], v[98:99]
    ds_write_b64 v111, v[96:97] offset:14336
    s_waitcnt lgkmcnt(0)
    s_barrier
    ds_read_b32 v80, v112 offset:14336
    ds_read_b32 v81, v112 offset:14400
    ds_read_b32 v82, v112 offset:14464
    ds_read_b32 v83, v112 offset:14528
    s_waitcnt lgkmcnt(0)
    v_add_f32 v80, v80, v81
    v_add_f32 v82, v82, v83
    v_cvt_pk_bf16_f32 v83, v80, v82
    v_lshlrev_b32 v80, 16, v83
    v_and_b32 v82, 0xffff0000, v83
    v_mul_f32 v81, s4, v80
    v_exp_f32 v81, v81
    s_nop 0
    v_add_f32 v81, 1.0, v81
    v_rcp_f32 v81, v81
    s_nop 0
    v_mul_f32 v80, v80, v81
    v_cvt_pk_bf16_f32 v80, v80, v80
    v_and_b32 v80, 0xffff0000, v80
    v_mul_f32 v80, v80, v82
    v_cvt_pk_bf16_f32 v80, v80, v80
    v_and_b32 v80, 0xffff0000, v80
    v_cndmask_b32 v80, v3, v80, s[68:69]
    s_bfm_b64 exec, 18, 0
    ds_write_b32 v113, v80 offset:14592
    s_mov_b64 exec, -1
    s_waitcnt lgkmcnt(0)
    ds_read_b32 v80, v114 offset:14592
    ds_read_b32 v81, v114 offset:14604
    ds_read_b32 v82, v114 offset:14616
    ds_read_b32 v83, v114 offset:14628
    ds_read_b32 v84, v114 offset:14640
    ds_read_b32 v85, v114 offset:14652
    s_waitcnt lgkmcnt(4)
    v_perm_b32 v86, v81, v80, s75
    v_dot2_f32_bf16 v96, v232, v86, 0
    v_dot2_f32_bf16 v97, v236, v86, 0
    v_dot2_f32_bf16 v98, v233, v86, 0
    v_dot2_f32_bf16 v99, v237, v86, 0
    v_dot2_f32_bf16 v100, v234, v86, 0
    v_dot2_f32_bf16 v101, v238, v86, 0
    v_dot2_f32_bf16 v102, v235, v86, 0
    v_dot2_f32_bf16 v103, v239, v86, 0
    s_waitcnt lgkmcnt(2)
    v_perm_b32 v87, v83, v82, s75
    v_dot2_f32_bf16 v96, v240, v87, v96
    v_dot2_f32_bf16 v97, v244, v87, v97
    v_dot2_f32_bf16 v98, v241, v87, v98
    v_dot2_f32_bf16 v99, v245, v87, v99
    v_dot2_f32_bf16 v100, v242, v87, v100
    v_dot2_f32_bf16 v101, v246, v87, v101
    v_dot2_f32_bf16 v102, v243, v87, v102
    v_dot2_f32_bf16 v103, v247, v87, v103
    s_waitcnt lgkmcnt(0)
    v_perm_b32 v86, v85, v84, s75
    v_dot2_f32_bf16 v96, v248, v86, v96
    v_dot2_f32_bf16 v97, v252, v86, v97
    v_dot2_f32_bf16 v98, v249, v86, v98
    v_dot2_f32_bf16 v99, v253, v86, v99
    v_dot2_f32_bf16 v100, v250, v86, v100
    v_dot2_f32_bf16 v101, v254, v86, v101
    v_dot2_f32_bf16 v102, v251, v86, v102
    v_dot2_f32_bf16 v103, v255, v86, v103
    s_mov_b64 exec, s[70:71]
    s_nop 1
    ds_write_b128 v115, v[96:99] offset:15104
    ds_write_b128 v115, v[100:103] offset:15120
    s_mov_b64 exec, -1
    s_waitcnt lgkmcnt(0)
    s_barrier
    s_cmp_ge_u32 s3, 3
    s_cbranch_scc1 L_md_93
    s_mov_b64 exec, s[72:73]
    ds_read_b128 v[80:83], v116 offset:15104
    ds_read_b128 v[84:87], v116 offset:17664
    ds_read_b128 v[88:91], v116 offset:20224
    s_waitcnt lgkmcnt(0)
    v_pk_add_f32 v[80:81], v[80:81], v[84:85]
    v_pk_add_f32 v[82:83], v[82:83], v[86:87]
    v_pk_add_f32 v[80:81], v[80:81], v[88:89]
    v_pk_add_f32 v[82:83], v[82:83], v[90:91]
    buffer_store_dwordx4 v[80:83], v117, s[16:19], s74 offen sc1
    s_mov_b64 exec, -1
L_md_93:
    s_cmp_ge_u32 s67, 40
    s_cbranch_scc1 L_fin_87
    v_dot2_f32_bf16 v57, v64, v181, 0
    v_dot2_f32_bf16 v57, v65, v182, v57
    v_dot2_f32_bf16 v57, v66, v183, v57
    v_dot2_f32_bf16 v57, v67, v184, v57
    v_dot2_f32_bf16 v57, v68, v185, v57
    s_mul_i32 s32, s67, 6144
    s_add_u32 s32, s32, 655360
    s_add_u32 s33, s32, 4096
    v_lshlrev_b32 v42, 3, v0
    s_nop 1
    v_add_f32_dpp v57, v57, v57 quad_perm:[1,0,3,2] row_mask:0xf bank_mask:0xf
    s_nop 1
    v_add_f32_dpp v57, v57, v57 quad_perm:[2,3,0,1] row_mask:0xf bank_mask:0xf
    s_nop 1
    v_add_f32_dpp v57, v57, v57 row_half_mirror row_mask:0xf bank_mask:0xf
    s_nop 1
    v_add_f32_dpp v57, v57, v57 row_mirror row_mask:0xf bank_mask:0xf
    v_mov_b32 v43, v57
    s_nop 1
    v_permlane16_swap_b32 v43, v57
    s_nop 0
    v_add_f32 v57, v57, v43
    v_mov_b32 v43, v57
    s_nop 1
    v_permlane32_swap_b32 v43, v57
    s_nop 0
    v_add_f32 v57, v57, v43
    v_cvt_pk_bf16_f32 v57, v57, v57
    v_and_b32 v57, 0xffff0000, v57
    v_mul_f32 v57, s31, v57
    v_sub_f32 v57, 0, v57
    v_exp_f32 v57, v57
    s_nop 0
    v_add_f32 v57, 1.0, v57
    v_rcp_f32 v57, v57
    s_nop 0
    v_cvt_pk_bf16_f32 v57, v57, v57
    v_and_b32 v57, 0xffff0000, v57
    v_and_b32 v44, 15, v0
    s_lshl_b32 s34, s67, 4
    v_add_u32 v44, s34, v44
    v_lshlrev_b32 v44, 1, v44
    ds_read_u16 v126, v44 offset:29696
    ds_read_u16 v127, v44 offset:24576
    s_mov_b32 s20, s56
    s_and_b32 s21, s57, 0xffff
    s_mov_b32 s22, 1280
    s_mov_b32 s23, 0x20000
    v_and_b32 v124, 7, v1
    v_lshlrev_b32 v124, 3, v124
    v_bfe_u32 v125, v1, 4, 1
    v_lshl_add_u32 v124, v125, 2, v124
    s_lshl_b32 s34, s3, 6
    v_add_u32 v124, s34, v124
    v_and_b32 v125, 15, v0
    v_lshlrev_b32 v125, 2, v125
    s_mov_b32 s66, 0
L_fspin_94:
    buffer_load_dwordx2 v[80:81], v42, s[16:19], s32 offen sc1
    buffer_load_dwordx2 v[82:83], v42, s[16:19], s32 offen offset:2048 sc1
    buffer_load_dwordx2 v[84:85], v42, s[16:19], s33 offen sc1
    s_waitcnt vmcnt(0)
    v_max3_u32 v43, v80, v81, v82
    v_max3_u32 v43, v43, v83, v84
    v_max_u32 v43, v43, v85
    v_cmp_eq_u32 vcc, -1, v43
    s_cbranch_vccz L_ok_95
    s_add_u32 s66, s66, 1
    s_cmp_lt_u32 s66, 200000
    s_cbranch_scc1 L_fspin_94
L_ok_95:
    v_add_f32 v100, v80, v82
    v_add_f32 v101, v81, v83
    v_add_f32 v100, v100, v84
    v_add_f32 v101, v101, v85
    s_nop 1
    v_add_f32_dpp v100, v100, v100 row_ror:8 row_mask:0xf bank_mask:0xf
    v_add_f32_dpp v101, v101, v101 row_ror:8 row_mask:0xf bank_mask:0xf
    s_nop 1
    v_permlane16_swap_b32 v100, v101
    s_nop 0
    v_add_f32 v100, v100, v101
    v_mov_b32 v101, v100
    s_nop 1
    v_permlane32_swap_b32 v100, v101
    s_nop 0
    v_add_f32 v100, v100, v101
    ds_write_b32 v124, v100 offset:3072
    s_waitcnt lgkmcnt(0)
    s_barrier
    s_cmp_ge_u32 s3, 1
    s_cbranch_scc1 L_fd_96
    ds_read_b32 v104, v125 offset:3072
    ds_read_b32 v105, v125 offset:3136
    ds_read_b32 v106, v125 offset:3200
    ds_read_b32 v107, v125 offset:3264
    v_lshlrev_b32 v120, 16, v126
    v_lshlrev_b32 v121, 16, v127
    s_bfm_b64 exec, 16, 0
    s_waitcnt lgkmcnt(0)
    v_add_f32 v104, v104, v105
    v_add_f32 v106, v106, v107
    v_add_f32 v104, v104, v106
    v_cvt_pk_bf16_f32 v104, v104, v104
    v_and_b32 v104, 0xffff0000, v104
    v_mul_f32 v104, v104, v57
    v_cvt_pk_bf16_f32 v104, v104, v104
    v_and_b32 v104, 0xffff0000, v104
    v_add_f32 v104, v121, v104
    v_cvt_pk_bf16_f32 v104, v104, v104
    v_and_b32 v104, 0xffff0000, v104
    v_add_f32 v104, v120, v104
    v_cvt_pk_bf16_f32 v104, v104, v104
    buffer_store_short v104, v44, s[20:23], 0 offen
    s_mov_b64 exec, -1
L_fd_96:
L_fin_87:
    s_waitcnt vmcnt(0) lgkmcnt(0)
    s_waitcnt vmcnt(0)
L_end_1:
    s_endpgm
L_code_end:
.section .rodata,"a"
.p2align 6
.amdhsa_kernel sequential_preLN__mha_block_cached__moe_arch_mod__decode_kernel
  .amdhsa_next_free_vgpr 256
  .amdhsa_next_free_sgpr 102
  .amdhsa_accum_offset 256
  .amdhsa_group_segment_fixed_size 0
  .amdhsa_kernarg_size 104
  .amdhsa_user_sgpr_count 2
  .amdhsa_user_sgpr_kernarg_segment_ptr 1
  .amdhsa_system_sgpr_workgroup_id_x 1
.end_amdhsa_kernel
```
